```python
import torch

def _softmax(x, axis=-1):
    return torch.softmax(x, dim=axis)
def _gelu(x):
    return torch.nn.functional.gelu(x, approximate="tanh")
def _silu(x):
    return torch.nn.functional.silu(x)
def _sigmoid(x):
    return torch.sigmoid(x)
def _layernorm(x, axis=-1, eps=1e-5):
    m = x.mean(dim=axis, keepdim=True)
    v = x.var(dim=axis, keepdim=True, unbiased=False)
    return (x - m) / torch.sqrt(v + eps)
def _scatter_add(tgt, idx, src, axis=0):
    return tgt.clone().index_add_(axis, idx, src)
def _segment_sum(src, seg, n):
    out = torch.zeros((n,) + src.shape[1:], dtype=src.dtype)
    return out.index_add_(0, seg, src)
def _pad(x, pw):
    flat = tuple(v for pair in reversed(pw) for v in pair)
    return torch.nn.functional.pad(x, flat)

kernel_name = 'sequential_preLN__ssm_conv_s4d__geglu_ffn__prompt'

def setup_inputs():

    _w = (lambda a: (lambda t: t.to(torch.bfloat16) if t.is_floating_point() else t)(torch.as_tensor(a)))
    def _A_setup():
        Bsz, L, D, N = 1, 2048, 640, 192
        return {
            "u": _w((lambda *s: torch.randn(*s, dtype=torch.bfloat16) * 0.05)(Bsz, L, D)),
            "log_A_real": _w((lambda *s: torch.randn(*s, dtype=torch.bfloat16) * 6.4)(D, N) * 0.5),
            "A_imag": _w((lambda *s: torch.randn(*s, dtype=torch.bfloat16) * 0.05)(D, N) * 3.14),
            "C_real": _w((lambda *s: torch.randn(*s, dtype=torch.bfloat16) * 0.05)(D, N) / N ** 0.5),
            "C_imag": _w((lambda *s: torch.randn(*s, dtype=torch.bfloat16) * 0.05)(D, N) / N ** 0.5),
            "log_dt": _w((lambda *s: torch.randn(*s, dtype=torch.bfloat16) * 0.05)(D) * 0.5 - 4.0),
            "D_skip": _w((lambda *s: torch.randn(*s, dtype=torch.bfloat16) * 0.05)(D)),
        }
    _A_in = _A_setup()

    def _B_setup():
        B, S, D, F = 1, 2048, 640, 1536
        return {
            "x": _w((lambda *s: torch.randn(*s, dtype=torch.bfloat16) * 0.05)(B, S, D)),
            "w_gate": _w((lambda *s: torch.randn(*s, dtype=torch.bfloat16) * 0.05)(D, F)),
            "w_up": _w((lambda *s: torch.randn(*s, dtype=torch.bfloat16) * 0.05)(D, F)),
            "w_down": _w((lambda *s: torch.randn(*s, dtype=torch.bfloat16) * 0.05)(F, D)),
        }
    _B_in = _B_setup()

    return {
        "A_u": _A_in["u"],
        "A_log_A_real": _A_in["log_A_real"],
        "A_A_imag": _A_in["A_imag"],
        "A_C_real": _A_in["C_real"],
        "A_C_imag": _A_in["C_imag"],
        "A_log_dt": _A_in["log_dt"],
        "A_D_skip": _A_in["D_skip"],
        "B_x": _B_in["x"],
        "B_w_gate": _B_in["w_gate"],
        "B_w_up": _B_in["w_up"],
        "B_w_down": _B_in["w_down"],
    }

def reference(A_u, A_log_A_real, A_A_imag, A_C_real, A_C_imag, A_log_dt, A_D_skip, B_x, B_w_gate, B_w_up, B_w_down):
    def _A_ref(u, log_A_real, A_imag, C_real, C_imag, log_dt, D_skip):
        L = u.shape[1]
        dt = torch.exp(log_dt)
        A = -torch.exp(log_A_real) + 1j * A_imag
        C = (C_real + 1j * C_imag) * dt[:, None]
        pos = (lambda x, dt: x.to(dt))(torch.arange(L), log_dt.dtype)
        P = torch.exp((A * dt[:, None])[:, :, None] * pos[None, None, :])
        K = 2.0 * torch.einsum("dn,dnl->dl", C, P).real
        L2 = 2 * L
        u_t = (lambda x, *d: x.permute(*d))(u, 0, 2, 1)
        Kf = (lambda x, *a, **k: torch.fft.rfft(x.float(), *a, **k))(K, L2)
        Uf = (lambda x, *a, **k: torch.fft.rfft(x.float(), *a, **k))(u_t, L2)
        y = (lambda x, *a, **k: torch.fft.irfft(x, *a, **k).to(torch.bfloat16))(Uf * Kf[None, :, :], L2)[:, :, :L]
        y = (lambda x, *d: x.permute(*d))(y, 0, 2, 1)
        return y + u * D_skip[None, None, :]

    def _B_ref(x, w_gate, w_up, w_down):
        return (_gelu(x @ w_gate) * (x @ w_up)) @ w_down

    x = A_u
    h = x + _A_ref(_layernorm(x, axis=-1), A_log_A_real, A_A_imag, A_C_real, A_C_imag, A_log_dt, A_D_skip)
    h2 = h + _B_ref(_layernorm(h, axis=-1), B_w_gate, B_w_up, B_w_down)
    return h2
```

```asm
; @launch kernel=kA_kernel grid=(256,1,1) block=(768,1,1) lds=155968
; @launch kernel=kC_kernel grid=(256,1,1) block=(256,1,1) lds=163840
.amdgcn_target "amdgcn-amd-amdhsa--gfx950"
.text
.globl kA_kernel
.p2align 8
.type kA_kernel,@function
kA_kernel:
  s_cmp_ge_u32 s2, 256
  s_cbranch_scc1 F_end
  s_add_u32 s2, s2, 255
  s_and_b32 s2, s2, 255
  s_load_dwordx2 s[4:5], s[0:1], 104
  s_mov_b32 s6, 23199744
  s_mov_b32 s7, 0x00020000
  v_lshrrev_b32 v1, 6, v0
  v_and_b32 v2, 63, v0
  v_readfirstlane_b32 s62, v1
  s_lshr_b32 s60, s2, 3
  s_mul_i32 s61, s60, 26
  s_lshr_b32 s61, s61, 8
  s_mul_i32 s14, s61, 10
  s_sub_u32 s60, s60, s14
  s_and_b32 s14, s2, 7
  s_mul_i32 s14, s14, 10
  s_add_u32 s60, s60, s14
  s_cmp_ge_u32 s62, 9
  s_cbranch_scc1 F_side
  s_cmp_ge_u32 s2, 240
  s_cbranch_scc1 F_init
  s_mul_i32 s26, s62, 86
  s_lshr_b32 s26, s26, 8
  s_mul_i32 s3, s26, 3
  s_sub_u32 s3, s62, s3
  s_mul_i32 s14, s61, 3
  s_add_u32 s14, s14, s26
  s_cmp_eq_u32 s14, 8
  s_cbranch_scc1 F_idle
  s_lshl_b32 s2, s60, 3
  s_add_u32 s2, s2, s14
  s_lshl_b32 s14, s3, 6
  v_add_u32 v0, s14, v2
  s_load_dwordx8 s[8:15], s[0:1], 8
  s_load_dwordx4 s[16:19], s[0:1], 40
  s_mul_i32 s20, s2, 384
  v_lshlrev_b32 v3, 1, v0
  v_add_u32 v3, s20, v3
  s_lshl_b32 s21, s2, 1
  v_mov_b32 v4, s21
  s_getpc_b64 s[22:23]
A_pc1:
  s_add_u32 s22, s22, A_tab-A_pc1
  s_addc_u32 s23, s23, 0
  v_lshlrev_b32 v5, 4, v0
  s_waitcnt lgkmcnt(0)
  global_load_ushort v10, v4, s[16:17]
  global_load_ushort v6, v3, s[8:9]
  global_load_ushort v7, v3, s[10:11]
  global_load_ushort v8, v3, s[12:13]
  global_load_ushort v9, v3, s[14:15]
  global_load_ushort v11, v4, s[18:19]
  global_load_dwordx4 v[12:15], v5, s[22:23]
  v_mov_b32 v21, s62
  v_lshl_add_u32 v20, v21, 6, v2
  v_lshrrev_b32 v24, 3, v2
  v_and_b32 v25, 7, v2
  v_lshrrev_b32 v26, 4, v2
  v_and_b32 v27, 1, v21
  v_lshl_add_u32 v27, v27, 2, v26
  v_xor_b32 v27, v25, v27
  v_mul_u32_u24 v24, 10240, v24
  v_lshl_add_u32 v156, v27, 4, v24
  s_lshl_b32 s32, s60, 7
  s_add_u32 s64, s32, 23183360
  s_mul_i32 s56, s62, 81920
  s_add_u32 s32, s32, s56
  s_lshl_b32 s56, s62, 10
  v_lshlrev_b32 v157, 4, v2
  v_add_u32 v158, s56, v157
  v_add_u32 v160, 61440, v158
  v_lshlrev_b32 v161, 3, v20
  s_lshl_b32 s52, s60, 3
  s_add_u32 s52, s52, s62
  s_mul_i32 s52, s52, 3072
  s_add_u32 s52, s52, 2621440
  s_mul_i32 s53, s62, 3072
  s_add_u32 s53, s53, 36864
  v_add_u32 v159, s53, v157
  s_lshl_b32 s65, s61, 2
  s_add_u32 s65, s65, s64
  s_lshl_b32 s56, s26, 2
  s_add_u32 s64, s64, s56
  s_mov_b32 s40, s4
  s_mov_b32 s41, s5
  s_cmp_ge_u32 s61, 1
  s_cselect_b32 s42, s6, 0
  s_mov_b32 s43, s7
  s_mov_b32 s44, s4
  s_mov_b32 s45, s5
  s_cmp_eq_u32 s61, 2
  s_cselect_b32 s46, s6, 0
  s_mov_b32 s47, s7
  s_mov_b32 s48, s4
  s_mov_b32 s49, s5
  s_cmp_eq_u32 s61, 0
  s_cselect_b32 s50, s6, 0
  s_mov_b32 s51, s7
  s_lshl_b32 s57, s61, 9
  s_add_u32 s57, s57, 512
  s_cmp_eq_u32 s61, 0
  s_cselect_b32 s57, 0, s57
  s_mul_i32 s36, s57, 1280
  s_add_u32 s36, s36, s32
  s_add_u32 s36, s36, 20545536
  s_add_u32 s37, s36, 655360
  s_add_u32 s33, s32, 655360
  s_add_u32 s34, s32, 1310720
  s_add_u32 s35, s32, 1966080
  v_add_u32 v22, s57, v20
  v_lshlrev_b32 v131, 4, v22
  s_lshl_b32 s54, s60, 15
  s_add_u32 s54, s54, 4587520
  s_add_u32 s55, s54, 8192
  v_mov_b32 v162, 154368
  v_mov_b32 v163, 1
  s_cmp_eq_u32 s62, 8
  s_cbranch_scc1 F_e8
  v_and_b32 v23, 15, v2
  v_lshl_add_u32 v22, v23, 1, v26
  v_add_u32 v25, 30, v22
  v_bfe_u32 v24, v25, 1, 3
  v_xor_b32 v24, v24, v21
  v_lshlrev_b32 v25, 7, v25
  v_lshl_add_u32 v120, v24, 4, v25
  v_add_u32 v120, 98560, v120
  v_add_u32 v25, 34, v22
  v_bfe_u32 v24, v25, 1, 3
  v_xor_b32 v24, v24, v21
  v_lshlrev_b32 v25, 7, v25
  v_lshl_add_u32 v121, v24, 4, v25
  v_add_u32 v121, 98560, v121
  v_add_u32 v25, 38, v22
  v_bfe_u32 v24, v25, 1, 3
  v_xor_b32 v24, v24, v21
  v_lshlrev_b32 v25, 7, v25
  v_lshl_add_u32 v122, v24, 4, v25
  v_add_u32 v122, 98560, v122
  v_add_u32 v25, 42, v22
  v_bfe_u32 v24, v25, 1, 3
  v_xor_b32 v24, v24, v21
  v_lshlrev_b32 v25, 7, v25
  v_lshl_add_u32 v123, v24, 4, v25
  v_add_u32 v123, 98560, v123
  v_add_u32 v25, 29, v22
  v_bfe_u32 v24, v25, 1, 3
  v_xor_b32 v24, v24, v21
  v_lshlrev_b32 v25, 7, v25
  v_lshl_add_u32 v124, v24, 4, v25
  v_add_u32 v124, 98560, v124
  v_mov_b32 v28, 0
  v_mov_b32 v29, 0
  v_add_u32 v161, 98560, v161
  ds_write_b64 v161, v[28:29]
  v_sub_u32 v25, 15, v23
  v_lshrrev_b32 v25, 1, v25
  v_lshl_add_u32 v25, v26, 2, v25
  v_and_b32 v24, 1, v23
  v_xor_b32 v24, 1, v24
  v_mul_u32_u24 v24, 464, v24
  v_add_u32 v25, v25, v24
  v_lshl_add_u32 v125, v25, 2, s53
  v_add_u32 v126, 512, v125
  v_sub_u32 v25, 295, v23
  v_lshl_add_u32 v25, v26, 2, v25
  v_lshl_add_u32 v127, v25, 2, s53
  s_mul_i32 s56, s62, 2112
  s_add_u32 s56, s56, 77824
  v_lshlrev_b32 v25, 5, v23
  v_lshl_add_u32 v25, v26, 3, v25
  v_add_u32 v128, s56, v25
  v_bfe_u32 v25, v2, 2, 2
  v_mul_u32_u24 v25, 2112, v25
  v_and_b32 v24, 3, v2
  v_lshl_add_u32 v25, v24, 3, v25
  v_lshrrev_b32 v24, 4, v20
  v_lshl_add_u32 v25, v24, 5, v25
  v_add_u32 v129, 77824, v25
  v_lshlrev_b32 v25, 3, v26
  v_sub_u32 v25, v23, v25
  v_add_u32 v24, 15, v25
  v_add_u32 v25, 16, v25
  v_and_b32 v25, 0xffff, v25
  v_lshl_or_b32 v25, v24, 16, v25
  s_mov_b32 s39, 0x3f803f80
  v_pk_sub_i16 v40, v25, 3 op_sel_hi:[1,0]
  v_pk_sub_i16 v41, v25, 4 op_sel_hi:[1,0]
  v_pk_sub_i16 v42, v25, 5 op_sel_hi:[1,0]
  v_pk_sub_i16 v43, v25, 6 op_sel_hi:[1,0]
  v_pk_sub_i16 v44, v25, 7 op_sel_hi:[1,0]
  v_pk_sub_i16 v45, v25, 8 op_sel_hi:[1,0]
  v_pk_sub_i16 v46, v25, 9 op_sel_hi:[1,0]
  v_pk_sub_i16 v47, v25, 10 op_sel_hi:[1,0]
  v_pk_sub_i16 v48, v25, 11 op_sel_hi:[1,0]
  v_pk_sub_i16 v49, v25, 12 op_sel_hi:[1,0]
  v_pk_sub_i16 v50, v25, 13 op_sel_hi:[1,0]
  v_pk_sub_i16 v51, v25, 14 op_sel_hi:[1,0]
  v_pk_sub_i16 v52, v25, 15 op_sel_hi:[1,0]
  v_pk_sub_i16 v53, v25, 16 op_sel_hi:[1,0]
  v_pk_sub_i16 v54, v25, 17 op_sel_hi:[1,0]
  v_pk_sub_i16 v55, v25, 18 op_sel_hi:[1,0]
  v_pk_sub_i16 v56, v25, 19 op_sel_hi:[1,0]
  v_pk_sub_i16 v57, v25, 20 op_sel_hi:[1,0]
  v_pk_ashrrev_i16 v40, 15, v40 op_sel_hi:[0,1]
  v_pk_ashrrev_i16 v41, 15, v41 op_sel_hi:[0,1]
  v_pk_ashrrev_i16 v42, 15, v42 op_sel_hi:[0,1]
  v_pk_ashrrev_i16 v43, 15, v43 op_sel_hi:[0,1]
  v_pk_ashrrev_i16 v44, 15, v44 op_sel_hi:[0,1]
  v_pk_ashrrev_i16 v45, 15, v45 op_sel_hi:[0,1]
  v_pk_ashrrev_i16 v46, 15, v46 op_sel_hi:[0,1]
  v_pk_ashrrev_i16 v47, 15, v47 op_sel_hi:[0,1]
  v_pk_ashrrev_i16 v48, 15, v48 op_sel_hi:[0,1]
  v_pk_ashrrev_i16 v49, 15, v49 op_sel_hi:[0,1]
  v_pk_ashrrev_i16 v50, 15, v50 op_sel_hi:[0,1]
  v_pk_ashrrev_i16 v51, 15, v51 op_sel_hi:[0,1]
  v_pk_ashrrev_i16 v52, 15, v52 op_sel_hi:[0,1]
  v_pk_ashrrev_i16 v53, 15, v53 op_sel_hi:[0,1]
  v_pk_ashrrev_i16 v54, 15, v54 op_sel_hi:[0,1]
  v_pk_ashrrev_i16 v55, 15, v55 op_sel_hi:[0,1]
  v_pk_ashrrev_i16 v56, 15, v56 op_sel_hi:[0,1]
  v_pk_ashrrev_i16 v57, 15, v57 op_sel_hi:[0,1]
  v_bitop3_b32 v132, v40, v43, s39 bitop3:0x28
  v_bitop3_b32 v133, v42, v45, s39 bitop3:0x28
  v_bitop3_b32 v134, v44, v47, s39 bitop3:0x28
  v_bitop3_b32 v135, v46, v49, s39 bitop3:0x28
  v_bitop3_b32 v136, v43, v48, s39 bitop3:0x28
  v_bitop3_b32 v137, v45, v50, s39 bitop3:0x28
  v_bitop3_b32 v138, v47, v52, s39 bitop3:0x28
  v_bitop3_b32 v139, v49, v54, s39 bitop3:0x28
  v_bitop3_b32 v140, v48, v51, s39 bitop3:0x28
  v_bitop3_b32 v141, v50, v53, s39 bitop3:0x28
  v_bitop3_b32 v142, v52, v55, s39 bitop3:0x28
  v_bitop3_b32 v143, v54, v57, s39 bitop3:0x28
  v_bitop3_b32 v144, v42, v49, s39 bitop3:0x28
  v_bitop3_b32 v145, v44, v51, s39 bitop3:0x28
  v_bitop3_b32 v146, v46, v53, s39 bitop3:0x28
  v_bitop3_b32 v147, v48, v55, s39 bitop3:0x28
  v_bitop3_b32 v148, v41, v50, s39 bitop3:0x28
  v_bitop3_b32 v149, v43, v52, s39 bitop3:0x28
  v_bitop3_b32 v150, v45, v54, s39 bitop3:0x28
  v_bitop3_b32 v151, v47, v56, s39 bitop3:0x28
  v_xor_b32 v152, v40, v42
  v_xor_b32 v153, v42, v44
  v_xor_b32 v154, v44, v46
  v_xor_b32 v155, v46, v48
  v_lshlrev_b32 v130, 4, v20
  v_add_u32 v130, 137984, v130
F_e8:
  s_barrier
  s_mul_i32 s27, s26, 27648
  s_add_u32 s27, s27, 4864
  s_mul_i32 s24, s3, 9216
  s_add_u32 s24, s24, s27
  s_mul_i32 s28, s26, 1600
  s_mul_i32 s29, s28, 0x10001
  v_lshl_add_u32 v16, v2, 2, s24
  v_and_b32 v17, 15, v2
  v_mul_u32_u24 v17, 288, v17
  v_lshrrev_b32 v18, 4, v2
  v_lshl_add_u32 v17, v18, 4, v17
  v_add_u32 v17, s24, v17
  v_mov_b32 v18, 0x3f80
  ds_write_b32 v16, v18 offset:4608
  v_mov_b32 v18, 0
  v_mov_b32 v19, s28
  ds_write_b32 v19, v18 offset:1536
  s_mul_i32 s25, s2, 3072
  s_add_u32 s25, s25, 2621440
  s_waitcnt vmcnt(6)
  v_lshlrev_b32 v10, 16, v10
  s_waitcnt vmcnt(5)
  v_lshlrev_b32 v6, 16, v6
  v_mul_f32 v10, 0x3fb8aa3b, v10
  v_mul_f32 v6, 0x3fb8aa3b, v6
  v_exp_f32 v10, v10
  v_exp_f32 v6, v6
  s_waitcnt vmcnt(4)
  v_lshlrev_b32 v7, 16, v7
  v_cvt_pk_bf16_f32 v6, v6, v10
  v_and_b32 v10, 0xffff0000, v6
  v_lshlrev_b32 v6, 16, v6
  v_mul_f32 v6, v6, v10
  v_mul_f32 v7, v7, v10
  v_mul_f32 v6, 0xbfb8aa3b, v6
  v_mul_f32 v7, 0.15915494, v7
  v_mul_f32 v18, 0x43000000, v6
  v_mul_f32 v19, 0x43000000, v7
  v_fract_f32 v7, v7
  v_fract_f32 v19, v19
  v_exp_f32 v6, v6
  v_exp_f32 v18, v18
  v_cos_f32 v20, v7
  v_sin_f32 v21, v7
  v_cos_f32 v36, v19
  v_sin_f32 v37, v19
  s_waitcnt vmcnt(3)
  v_lshlrev_b32 v8, 16, v8
  s_waitcnt vmcnt(2)
  v_lshlrev_b32 v9, 16, v9
  v_add_f32 v10, v10, v10
  v_pk_mul_f32 v[20:21], v[20:21], v[6:7] op_sel_hi:[1,0]
  v_pk_mul_f32 v[36:37], v[36:37], v[18:19] op_sel_hi:[1,0]
  s_waitcnt vmcnt(1)
  v_pk_mul_f32 v[8:9], v[8:9], v[10:11] op_sel_hi:[1,0]
  v_pk_mul_f32 v[56:57], v[20:21], v[20:21] op_sel:[0,0] op_sel_hi:[0,1]
  v_cvt_pk_bf16_f32 v58, v36, v37
  v_pk_fma_f32 v[22:23], v[20:21], v[20:21], v[56:57] op_sel:[1,1,0] op_sel_hi:[1,0,1] neg_lo:[0,1,0]
  ds_write_b32 v16, v58 offset:4896
  v_pk_mul_f32 v[54:55], v[22:23], v[22:23] op_sel:[0,0] op_sel_hi:[0,1]
  v_pk_mul_f32 v[50:51], v[36:37], v[36:37] op_sel:[0,0] op_sel_hi:[0,1]
  v_pk_fma_f32 v[24:25], v[22:23], v[22:23], v[54:55] op_sel:[1,1,0] op_sel_hi:[1,0,1] neg_lo:[0,1,0]
  v_pk_fma_f32 v[38:39], v[36:37], v[36:37], v[50:51] op_sel:[1,1,0] op_sel_hi:[1,0,1] neg_lo:[0,1,0]
  v_pk_mul_f32 v[56:57], v[24:25], v[24:25] op_sel:[0,0] op_sel_hi:[0,1]
  v_cvt_pk_bf16_f32 v59, v38, v39
  v_pk_fma_f32 v[26:27], v[24:25], v[24:25], v[56:57] op_sel:[1,1,0] op_sel_hi:[1,0,1] neg_lo:[0,1,0]
  ds_write_b32 v16, v59 offset:5184
  v_cvt_pk_bf16_f32 v61, v8, -v9
  v_pk_mul_f32 v[52:53], v[38:39], v[36:37] op_sel:[0,0] op_sel_hi:[0,1]
  ds_write_b32 v16, v61 offset:0
  v_pk_fma_f32 v[40:41], v[38:39], v[36:37], v[52:53] op_sel:[1,1,0] op_sel_hi:[1,0,1] neg_lo:[0,1,0]
  v_pk_mul_f32 v[54:55], v[8:9], v[26:27] op_sel:[0,0] op_sel_hi:[0,1]
  v_cvt_pk_bf16_f32 v58, v40, v41
  v_pk_fma_f32 v[66:67], v[8:9], v[26:27], v[54:55] op_sel:[1,1,0] op_sel_hi:[1,0,1] neg_lo:[0,1,0]
  ds_write_b32 v16, v58 offset:5472
  v_cvt_pk_bf16_f32 v60, v66, -v67
  v_pk_mul_f32 v[50:51], v[40:41], v[36:37] op_sel:[0,0] op_sel_hi:[0,1]
  ds_write_b32 v16, v60 offset:288
  v_pk_fma_f32 v[42:43], v[40:41], v[36:37], v[50:51] op_sel:[1,1,0] op_sel_hi:[1,0,1] neg_lo:[0,1,0]
  v_pk_mul_f32 v[56:57], v[66:67], v[26:27] op_sel:[0,0] op_sel_hi:[0,1]
  v_cvt_pk_bf16_f32 v59, v42, v43
  v_pk_fma_f32 v[68:69], v[66:67], v[26:27], v[56:57] op_sel:[1,1,0] op_sel_hi:[1,0,1] neg_lo:[0,1,0]
  ds_write_b32 v16, v59 offset:5760
  v_cvt_pk_bf16_f32 v61, v68, -v69
  v_pk_mul_f32 v[52:53], v[42:43], v[36:37] op_sel:[0,0] op_sel_hi:[0,1]
  ds_write_b32 v16, v61 offset:576
  v_pk_fma_f32 v[44:45], v[42:43], v[36:37], v[52:53] op_sel:[1,1,0] op_sel_hi:[1,0,1] neg_lo:[0,1,0]
  v_pk_mul_f32 v[54:55], v[68:69], v[26:27] op_sel:[0,0] op_sel_hi:[0,1]
  v_cvt_pk_bf16_f32 v58, v44, v45
  v_pk_fma_f32 v[66:67], v[68:69], v[26:27], v[54:55] op_sel:[1,1,0] op_sel_hi:[1,0,1] neg_lo:[0,1,0]
  ds_write_b32 v16, v58 offset:6048
  v_cvt_pk_bf16_f32 v60, v66, -v67
  v_pk_mul_f32 v[50:51], v[44:45], v[36:37] op_sel:[0,0] op_sel_hi:[0,1]
  ds_write_b32 v16, v60 offset:864
  v_pk_fma_f32 v[46:47], v[44:45], v[36:37], v[50:51] op_sel:[1,1,0] op_sel_hi:[1,0,1] neg_lo:[0,1,0]
  v_pk_mul_f32 v[56:57], v[66:67], v[26:27] op_sel:[0,0] op_sel_hi:[0,1]
  v_cvt_pk_bf16_f32 v59, v46, v47
  v_pk_fma_f32 v[68:69], v[66:67], v[26:27], v[56:57] op_sel:[1,1,0] op_sel_hi:[1,0,1] neg_lo:[0,1,0]
  ds_write_b32 v16, v59 offset:6336
  v_cvt_pk_bf16_f32 v61, v68, -v69
  v_pk_mul_f32 v[52:53], v[46:47], v[36:37] op_sel:[0,0] op_sel_hi:[0,1]
  ds_write_b32 v16, v61 offset:1152
  v_pk_fma_f32 v[48:49], v[46:47], v[36:37], v[52:53] op_sel:[1,1,0] op_sel_hi:[1,0,1] neg_lo:[0,1,0]
  v_pk_mul_f32 v[54:55], v[68:69], v[26:27] op_sel:[0,0] op_sel_hi:[0,1]
  v_cvt_pk_bf16_f32 v58, v48, v49
  v_pk_fma_f32 v[66:67], v[68:69], v[26:27], v[54:55] op_sel:[1,1,0] op_sel_hi:[1,0,1] neg_lo:[0,1,0]
  ds_write_b32 v16, v58 offset:6624
  v_cvt_pk_bf16_f32 v60, v66, -v67
  v_pk_mul_f32 v[50:51], v[48:49], v[36:37] op_sel:[0,0] op_sel_hi:[0,1]
  ds_write_b32 v16, v60 offset:1440
  v_pk_fma_f32 v[64:65], v[48:49], v[36:37], v[50:51] op_sel:[1,1,0] op_sel_hi:[1,0,1] neg_lo:[0,1,0]
  v_pk_mul_f32 v[56:57], v[66:67], v[26:27] op_sel:[0,0] op_sel_hi:[0,1]
  v_cvt_pk_bf16_f32 v59, v64, v65
  v_pk_fma_f32 v[68:69], v[66:67], v[26:27], v[56:57] op_sel:[1,1,0] op_sel_hi:[1,0,1] neg_lo:[0,1,0]
  ds_write_b32 v16, v59 offset:6912
  v_cvt_pk_bf16_f32 v61, v68, -v69
  v_pk_mul_f32 v[52:53], v[64:65], v[36:37] op_sel:[0,0] op_sel_hi:[0,1]
  ds_write_b32 v16, v61 offset:1728
  v_pk_fma_f32 v[62:63], v[64:65], v[36:37], v[52:53] op_sel:[1,1,0] op_sel_hi:[1,0,1] neg_lo:[0,1,0]
  v_pk_mul_f32 v[54:55], v[68:69], v[26:27] op_sel:[0,0] op_sel_hi:[0,1]
  v_cvt_pk_bf16_f32 v58, v62, v63
  v_pk_fma_f32 v[66:67], v[68:69], v[26:27], v[54:55] op_sel:[1,1,0] op_sel_hi:[1,0,1] neg_lo:[0,1,0]
  ds_write_b32 v16, v58 offset:7200
  v_cvt_pk_bf16_f32 v60, v66, -v67
  v_pk_mul_f32 v[50:51], v[62:63], v[36:37] op_sel:[0,0] op_sel_hi:[0,1]
  ds_write_b32 v16, v60 offset:2016
  v_pk_fma_f32 v[64:65], v[62:63], v[36:37], v[50:51] op_sel:[1,1,0] op_sel_hi:[1,0,1] neg_lo:[0,1,0]
  v_pk_mul_f32 v[56:57], v[66:67], v[26:27] op_sel:[0,0] op_sel_hi:[0,1]
  v_cvt_pk_bf16_f32 v59, v64, v65
  v_pk_fma_f32 v[68:69], v[66:67], v[26:27], v[56:57] op_sel:[1,1,0] op_sel_hi:[1,0,1] neg_lo:[0,1,0]
  ds_write_b32 v16, v59 offset:7488
  v_cvt_pk_bf16_f32 v61, v68, -v69
  v_pk_mul_f32 v[52:53], v[64:65], v[36:37] op_sel:[0,0] op_sel_hi:[0,1]
  ds_write_b32 v16, v61 offset:2304
  v_pk_fma_f32 v[62:63], v[64:65], v[36:37], v[52:53] op_sel:[1,1,0] op_sel_hi:[1,0,1] neg_lo:[0,1,0]
  v_pk_mul_f32 v[54:55], v[68:69], v[26:27] op_sel:[0,0] op_sel_hi:[0,1]
  v_cvt_pk_bf16_f32 v58, v62, v63
  v_pk_fma_f32 v[66:67], v[68:69], v[26:27], v[54:55] op_sel:[1,1,0] op_sel_hi:[1,0,1] neg_lo:[0,1,0]
  ds_write_b32 v16, v58 offset:7776
  v_cvt_pk_bf16_f32 v60, v66, -v67
  v_pk_mul_f32 v[50:51], v[62:63], v[36:37] op_sel:[0,0] op_sel_hi:[0,1]
  ds_write_b32 v16, v60 offset:2592
  v_pk_fma_f32 v[64:65], v[62:63], v[36:37], v[50:51] op_sel:[1,1,0] op_sel_hi:[1,0,1] neg_lo:[0,1,0]
  v_pk_mul_f32 v[56:57], v[66:67], v[26:27] op_sel:[0,0] op_sel_hi:[0,1]
  v_cvt_pk_bf16_f32 v59, v64, v65
  v_pk_fma_f32 v[68:69], v[66:67], v[26:27], v[56:57] op_sel:[1,1,0] op_sel_hi:[1,0,1] neg_lo:[0,1,0]
  ds_write_b32 v16, v59 offset:8064
  v_cvt_pk_bf16_f32 v61, v68, -v69
  v_pk_mul_f32 v[52:53], v[64:65], v[36:37] op_sel:[0,0] op_sel_hi:[0,1]
  ds_write_b32 v16, v61 offset:2880
  v_pk_fma_f32 v[62:63], v[64:65], v[36:37], v[52:53] op_sel:[1,1,0] op_sel_hi:[1,0,1] neg_lo:[0,1,0]
  v_pk_mul_f32 v[54:55], v[68:69], v[26:27] op_sel:[0,0] op_sel_hi:[0,1]
  v_cvt_pk_bf16_f32 v58, v62, v63
  v_pk_fma_f32 v[66:67], v[68:69], v[26:27], v[54:55] op_sel:[1,1,0] op_sel_hi:[1,0,1] neg_lo:[0,1,0]
  ds_write_b32 v16, v58 offset:8352
  v_cvt_pk_bf16_f32 v60, v66, -v67
  v_pk_mul_f32 v[50:51], v[62:63], v[36:37] op_sel:[0,0] op_sel_hi:[0,1]
  ds_write_b32 v16, v60 offset:3168
  v_pk_fma_f32 v[64:65], v[62:63], v[36:37], v[50:51] op_sel:[1,1,0] op_sel_hi:[1,0,1] neg_lo:[0,1,0]
  v_pk_mul_f32 v[56:57], v[66:67], v[26:27] op_sel:[0,0] op_sel_hi:[0,1]
  v_cvt_pk_bf16_f32 v59, v64, v65
  v_pk_fma_f32 v[68:69], v[66:67], v[26:27], v[56:57] op_sel:[1,1,0] op_sel_hi:[1,0,1] neg_lo:[0,1,0]
  ds_write_b32 v16, v59 offset:8640
  v_cvt_pk_bf16_f32 v61, v68, -v69
  v_pk_mul_f32 v[52:53], v[64:65], v[36:37] op_sel:[0,0] op_sel_hi:[0,1]
  ds_write_b32 v16, v61 offset:3456
  v_pk_fma_f32 v[62:63], v[64:65], v[36:37], v[52:53] op_sel:[1,1,0] op_sel_hi:[1,0,1] neg_lo:[0,1,0]
  v_pk_mul_f32 v[54:55], v[68:69], v[26:27] op_sel:[0,0] op_sel_hi:[0,1]
  v_cvt_pk_bf16_f32 v58, v62, v63
  v_pk_fma_f32 v[66:67], v[68:69], v[26:27], v[54:55] op_sel:[1,1,0] op_sel_hi:[1,0,1] neg_lo:[0,1,0]
  ds_write_b32 v16, v58 offset:8928
  v_cvt_pk_bf16_f32 v60, v66, -v67
  v_pk_mul_f32 v[50:51], v[62:63], v[36:37] op_sel:[0,0] op_sel_hi:[0,1]
  ds_write_b32 v16, v60 offset:3744
  v_pk_fma_f32 v[64:65], v[62:63], v[36:37], v[50:51] op_sel:[1,1,0] op_sel_hi:[1,0,1] neg_lo:[0,1,0]
  v_pk_mul_f32 v[56:57], v[66:67], v[26:27] op_sel:[0,0] op_sel_hi:[0,1]
  v_pk_fma_f32 v[68:69], v[66:67], v[26:27], v[56:57] op_sel:[1,1,0] op_sel_hi:[1,0,1] neg_lo:[0,1,0]
  v_cvt_pk_bf16_f32 v61, v68, -v69
  ds_write_b32 v16, v61 offset:4032
  v_pk_mul_f32 v[54:55], v[68:69], v[26:27] op_sel:[0,0] op_sel_hi:[0,1]
  v_pk_fma_f32 v[66:67], v[68:69], v[26:27], v[54:55] op_sel:[1,1,0] op_sel_hi:[1,0,1] neg_lo:[0,1,0]
  v_cvt_pk_bf16_f32 v60, v66, -v67
  ds_write_b32 v16, v60 offset:4320
  ds_read_b128 v[72:75], v17 offset:0
  ds_read_b128 v[88:91], v17 offset:4608
  ds_read_b128 v[76:79], v17 offset:64
  ds_read_b128 v[92:95], v17 offset:4672
  ds_read_b128 v[80:83], v17 offset:128
  ds_read_b128 v[96:99], v17 offset:4736
  ds_read_b128 v[84:87], v17 offset:192
  ds_read_b128 v[100:103], v17 offset:4800
  v_cvt_pk_bf16_f32 v61, v64, v65
  v_pk_mul_f32 v[50:51], v[20:21], v[22:23] op_sel:[0,0] op_sel_hi:[0,1]
  ds_write_b32 v16, v61 offset:0
  v_pk_fma_f32 v[28:29], v[20:21], v[22:23], v[50:51] op_sel:[1,1,0] op_sel_hi:[1,0,1] neg_lo:[0,1,0]
  v_cvt_pk_bf16_f32 v60, v24, v25
  v_pk_mul_f32 v[52:53], v[20:21], v[24:25] op_sel:[0,0] op_sel_hi:[0,1]
  ds_write_b32 v16, v60 offset:288
  v_pk_fma_f32 v[30:31], v[20:21], v[24:25], v[52:53] op_sel:[1,1,0] op_sel_hi:[1,0,1] neg_lo:[0,1,0]
  v_cvt_pk_bf16_f32 v61, v22, v23
  v_pk_mul_f32 v[50:51], v[28:29], v[24:25] op_sel:[0,0] op_sel_hi:[0,1]
  ds_write_b32 v16, v61 offset:2592
  v_pk_fma_f32 v[34:35], v[28:29], v[24:25], v[50:51] op_sel:[1,1,0] op_sel_hi:[1,0,1] neg_lo:[0,1,0]
  v_pk_mul_f32 v[56:57], v[22:23], v[24:25] op_sel:[0,0] op_sel_hi:[0,1]
  v_pk_fma_f32 v[32:33], v[22:23], v[24:25], v[56:57] op_sel:[1,1,0] op_sel_hi:[1,0,1] neg_lo:[0,1,0]
  v_cvt_pk_bf16_f32 v60, v32, v33
  ds_write_b32 v16, v60 offset:3744
  s_waitcnt lgkmcnt(10)
  v_mfma_f32_16x16x32_bf16 v[104:107], v[88:91], v[72:75], 0
  s_waitcnt lgkmcnt(8)
  v_mfma_f32_16x16x32_bf16 v[104:107], v[92:95], v[76:79], v[104:107]
  s_waitcnt lgkmcnt(6)
  v_mfma_f32_16x16x32_bf16 v[104:107], v[96:99], v[80:83], v[104:107]
  s_waitcnt lgkmcnt(4)
  v_mfma_f32_16x16x32_bf16 v[104:107], v[100:103], v[84:87], v[104:107]
  v_pk_mul_f32 v[52:53], v[24:25], v[36:37] op_sel:[0,0] op_sel_hi:[0,1]
  v_pk_mul_f32 v[54:55], v[24:25], v[38:39] op_sel:[0,0] op_sel_hi:[0,1]
  v_pk_fma_f32 v[62:63], v[24:25], v[36:37], v[52:53] op_sel:[1,1,0] op_sel_hi:[1,0,1] neg_lo:[0,1,0]
  v_pk_fma_f32 v[66:67], v[24:25], v[38:39], v[54:55] op_sel:[1,1,0] op_sel_hi:[1,0,1] neg_lo:[0,1,0]
  v_cvt_pk_bf16_f32 v59, v62, v63
  v_cvt_pk_bf16_f32 v60, v66, v67
  ds_write_b32 v16, v59 offset:576
  ds_write_b32 v16, v60 offset:864
  v_pk_mul_f32 v[52:53], v[24:25], v[40:41] op_sel:[0,0] op_sel_hi:[0,1]
  v_pk_mul_f32 v[54:55], v[24:25], v[42:43] op_sel:[0,0] op_sel_hi:[0,1]
  v_pk_fma_f32 v[62:63], v[24:25], v[40:41], v[52:53] op_sel:[1,1,0] op_sel_hi:[1,0,1] neg_lo:[0,1,0]
  v_pk_fma_f32 v[66:67], v[24:25], v[42:43], v[54:55] op_sel:[1,1,0] op_sel_hi:[1,0,1] neg_lo:[0,1,0]
  v_cvt_pk_bf16_f32 v59, v62, v63
  v_cvt_pk_bf16_f32 v60, v66, v67
  ds_write_b32 v16, v59 offset:1152
  ds_write_b32 v16, v60 offset:1440
  v_pk_mul_f32 v[52:53], v[24:25], v[44:45] op_sel:[0,0] op_sel_hi:[0,1]
  v_pk_mul_f32 v[54:55], v[24:25], v[46:47] op_sel:[0,0] op_sel_hi:[0,1]
  v_pk_fma_f32 v[62:63], v[24:25], v[44:45], v[52:53] op_sel:[1,1,0] op_sel_hi:[1,0,1] neg_lo:[0,1,0]
  v_pk_fma_f32 v[66:67], v[24:25], v[46:47], v[54:55] op_sel:[1,1,0] op_sel_hi:[1,0,1] neg_lo:[0,1,0]
  v_cvt_pk_bf16_f32 v59, v62, v63
  v_cvt_pk_bf16_f32 v60, v66, v67
  ds_write_b32 v16, v59 offset:1728
  ds_write_b32 v16, v60 offset:2016
  v_pk_mul_f32 v[52:53], v[24:25], v[48:49] op_sel:[0,0] op_sel_hi:[0,1]
  v_pk_mul_f32 v[54:55], v[22:23], v[36:37] op_sel:[0,0] op_sel_hi:[0,1]
  v_pk_fma_f32 v[62:63], v[24:25], v[48:49], v[52:53] op_sel:[1,1,0] op_sel_hi:[1,0,1] neg_lo:[0,1,0]
  v_pk_fma_f32 v[66:67], v[22:23], v[36:37], v[54:55] op_sel:[1,1,0] op_sel_hi:[1,0,1] neg_lo:[0,1,0]
  v_cvt_pk_bf16_f32 v59, v62, v63
  v_cvt_pk_bf16_f32 v60, v66, v67
  ds_write_b32 v16, v59 offset:2304
  ds_write_b32 v16, v60 offset:2880
  v_pk_mul_f32 v[52:53], v[22:23], v[38:39] op_sel:[0,0] op_sel_hi:[0,1]
  v_pk_mul_f32 v[54:55], v[22:23], v[40:41] op_sel:[0,0] op_sel_hi:[0,1]
  v_pk_fma_f32 v[62:63], v[22:23], v[38:39], v[52:53] op_sel:[1,1,0] op_sel_hi:[1,0,1] neg_lo:[0,1,0]
  v_pk_fma_f32 v[66:67], v[22:23], v[40:41], v[54:55] op_sel:[1,1,0] op_sel_hi:[1,0,1] neg_lo:[0,1,0]
  v_cvt_pk_bf16_f32 v59, v62, v63
  v_cvt_pk_bf16_f32 v60, v66, v67
  ds_write_b32 v16, v59 offset:3168
  ds_write_b32 v16, v60 offset:3456
  v_pk_mul_f32 v[52:53], v[32:33], v[36:37] op_sel:[0,0] op_sel_hi:[0,1]
  v_pk_mul_f32 v[54:55], v[32:33], v[38:39] op_sel:[0,0] op_sel_hi:[0,1]
  v_pk_fma_f32 v[62:63], v[32:33], v[36:37], v[52:53] op_sel:[1,1,0] op_sel_hi:[1,0,1] neg_lo:[0,1,0]
  v_pk_fma_f32 v[66:67], v[32:33], v[38:39], v[54:55] op_sel:[1,1,0] op_sel_hi:[1,0,1] neg_lo:[0,1,0]
  v_cvt_pk_bf16_f32 v59, v62, v63
  v_cvt_pk_bf16_f32 v60, v66, v67
  ds_write_b32 v16, v59 offset:4032
  ds_write_b32 v16, v60 offset:4320
  ds_read_b128 v[88:91], v17 offset:0
  ds_read_b128 v[92:95], v17 offset:64
  ds_read_b128 v[96:99], v17 offset:128
  ds_read_b128 v[100:103], v17 offset:192
  v_cvt_pk_bf16_f32 v59, v20, v21
  v_cvt_pk_bf16_f32 v61, v28, v29
  ds_write_b32 v16, v59 offset:4896
  ds_write_b32 v16, v61 offset:5184
  v_cvt_pk_bf16_f32 v58, v30, v31
  v_cvt_pk_bf16_f32 v60, v34, v35
  ds_write_b32 v16, v58 offset:5472
  ds_write_b32 v16, v60 offset:5760
  v_pk_mul_f32 v[52:53], v[32:33], v[40:41] op_sel:[0,0] op_sel_hi:[0,1]
  v_pk_mul_f32 v[54:55], v[20:21], v[36:37] op_sel:[0,0] op_sel_hi:[0,1]
  v_pk_fma_f32 v[62:63], v[32:33], v[40:41], v[52:53] op_sel:[1,1,0] op_sel_hi:[1,0,1] neg_lo:[0,1,0]
  v_pk_fma_f32 v[66:67], v[20:21], v[36:37], v[54:55] op_sel:[1,1,0] op_sel_hi:[1,0,1] neg_lo:[0,1,0]
  v_cvt_pk_bf16_f32 v59, v62, v63
  v_cvt_pk_bf16_f32 v60, v66, v67
  ds_write_b32 v16, v59 offset:4608
  ds_write_b32 v16, v60 offset:6048
  v_pk_mul_f32 v[52:53], v[28:29], v[36:37] op_sel:[0,0] op_sel_hi:[0,1]
  v_pk_mul_f32 v[54:55], v[30:31], v[36:37] op_sel:[0,0] op_sel_hi:[0,1]
  v_pk_fma_f32 v[62:63], v[28:29], v[36:37], v[52:53] op_sel:[1,1,0] op_sel_hi:[1,0,1] neg_lo:[0,1,0]
  v_pk_fma_f32 v[66:67], v[30:31], v[36:37], v[54:55] op_sel:[1,1,0] op_sel_hi:[1,0,1] neg_lo:[0,1,0]
  v_cvt_pk_bf16_f32 v59, v62, v63
  v_cvt_pk_bf16_f32 v60, v66, v67
  ds_write_b32 v16, v59 offset:6336
  ds_write_b32 v16, v60 offset:6624
  v_pk_mul_f32 v[52:53], v[34:35], v[36:37] op_sel:[0,0] op_sel_hi:[0,1]
  v_pk_fma_f32 v[62:63], v[34:35], v[36:37], v[52:53] op_sel:[1,1,0] op_sel_hi:[1,0,1] neg_lo:[0,1,0]
  v_cvt_pk_bf16_f32 v59, v62, v63
  ds_write_b32 v16, v59 offset:6912
  ds_read_b128 v[32:35], v17 offset:4608
  ds_read_b128 v[36:39], v17 offset:4672
  ds_read_b128 v[40:43], v17 offset:4736
  ds_read_b128 v[44:47], v17 offset:4800
  s_waitcnt lgkmcnt(15)
  v_mfma_f32_16x16x32_bf16 v[108:111], v[88:91], v[72:75], 0
  v_mfma_f32_16x16x32_bf16 v[108:111], v[92:95], v[76:79], v[108:111]
  s_waitcnt lgkmcnt(14)
  v_mfma_f32_16x16x32_bf16 v[108:111], v[96:99], v[80:83], v[108:111]
  s_waitcnt lgkmcnt(13)
  v_mfma_f32_16x16x32_bf16 v[108:111], v[100:103], v[84:87], v[108:111]
  s_waitcnt lgkmcnt(3)
  v_mfma_f32_16x16x32_bf16 v[112:115], v[32:35], v[72:75], 0
  s_waitcnt lgkmcnt(2)
  v_mfma_f32_16x16x32_bf16 v[112:115], v[36:39], v[76:79], v[112:115]
  s_waitcnt lgkmcnt(1)
  v_mfma_f32_16x16x32_bf16 v[112:115], v[40:43], v[80:83], v[112:115]
  s_waitcnt lgkmcnt(0)
  v_mfma_f32_16x16x32_bf16 v[112:115], v[44:47], v[84:87], v[112:115]
  v_lshl_add_u32 v16, v2, 4, s24
  v_lshl_add_u32 v17, v0, 4, s27
  s_waitcnt vmcnt(0)
  v_add_u32 v12, s29, v12
  v_add_u32 v13, s29, v13
  v_add_u32 v14, s29, v14
  v_add_u32 v15, s29, v15
  ds_write_b128 v16, v[104:107] offset:0
  ds_write_b128 v16, v[108:111] offset:1024
  ds_write_b128 v16, v[112:115] offset:2048
  v_and_b32 v20, 0xffff, v12
  v_lshrrev_b32 v21, 16, v12
  v_and_b32 v22, 0xffff, v13
  v_lshrrev_b32 v23, 16, v13
  v_and_b32 v24, 0xffff, v14
  v_lshrrev_b32 v25, 16, v14
  v_and_b32 v26, 0xffff, v15
  v_lshrrev_b32 v27, 16, v15
  v_lshlrev_b32 v11, 16, v11
  v_cmp_eq_u32 vcc, 0, v0
  v_lshl_add_u32 v18, v0, 3, s28
  s_nop 0
  v_cndmask_b32 v11, 0, v11, vcc
  s_waitcnt lgkmcnt(0)
  s_barrier
  ds_read_b128 v[72:75], v17 offset:0
  ds_read_b128 v[76:79], v17 offset:9216
  ds_read_b128 v[80:83], v17 offset:18432
  s_waitcnt lgkmcnt(2)
  v_add_f32 v72, v72, v11
  s_waitcnt lgkmcnt(1)
  v_pk_add_f32 v[72:73], v[72:73], v[76:77]
  v_pk_add_f32 v[74:75], v[74:75], v[78:79]
  s_waitcnt lgkmcnt(0)
  v_pk_add_f32 v[72:73], v[72:73], v[80:81]
  v_pk_add_f32 v[74:75], v[74:75], v[82:83]
  v_cvt_pk_bf16_f32 v72, v72, v73
  v_cvt_pk_bf16_f32 v73, v74, v75
  ds_write_b64 v18, v[72:73]
  s_waitcnt lgkmcnt(0)
  s_barrier
  ds_read_u16 v28, v20
  ds_read_u16 v29, v21
  ds_read_u16 v30, v22
  ds_read_u16 v31, v23
  ds_read_u16 v32, v24
  ds_read_u16 v33, v25
  ds_read_u16 v34, v26
  ds_read_u16 v35, v27
  s_waitcnt lgkmcnt(6)
  v_lshl_or_b32 v12, v29, 16, v28
  s_waitcnt lgkmcnt(4)
  v_lshl_or_b32 v13, v31, 16, v30
  s_waitcnt lgkmcnt(2)
  v_lshl_or_b32 v14, v33, 16, v32
  s_waitcnt lgkmcnt(0)
  v_lshl_or_b32 v15, v35, 16, v34
  buffer_store_dwordx4 v[12:15], v5, s[4:7], s25 offen sc1
  s_cmp_eq_u32 s62, 8
  s_cbranch_scc1 F_m8
F_b:
  v_mov_b32 v4, 1
  v_mov_b32 v6, 0
  v_mov_b32 v7, 0
  s_mov_b32 s63, 0
  s_barrier
  buffer_load_dwordx4 v[76:79], v157, s[4:7], s52 offen offset:0 sc1
  buffer_load_dwordx4 v[80:83], v157, s[4:7], s52 offen offset:1024 sc1
  buffer_load_dwordx4 v[84:87], v157, s[4:7], s52 offen offset:2048 sc1
  s_barrier
F_dry:
  s_cmp_eq_u32 s61, 1
  s_cbranch_scc1 B_t1
  s_cmp_eq_u32 s61, 2
  s_cbranch_scc1 B_t2
B_t0:
  v_subrev_u32 v164, 2048, v120
  v_subrev_u32 v165, 4096, v121
  v_subrev_u32 v166, 4096, v122
  v_subrev_u32 v167, 4096, v123
  ds_read_b128 v[24:27], v120 offset:0
  ds_read_b128 v[28:31], v124 offset:0
  s_waitcnt lgkmcnt(1)
  v_mfma_f32_16x16x32_bf16 v[32:35], v[24:27], v[132:135], 0
  ds_read_b128 v[36:39], v120 offset:4096
  v_mfma_f32_16x16x32_bf16 v[40:43], v[24:27], v[136:139], 0
  v_mfma_f32_16x16x32_bf16 v[44:47], v[24:27], v[140:143], 0
  s_waitcnt lgkmcnt(1)
  v_mfma_f32_16x16x32_bf16 v[48:51], v[28:31], v[136:139], 0
  s_nop 4
  v_cvt_pk_bf16_f32 v32, v32, v40
  v_cvt_pk_bf16_f32 v33, v33, v41
  v_cvt_pk_bf16_f32 v34, v34, v42
  v_cvt_pk_bf16_f32 v35, v35, v43
  s_waitcnt lgkmcnt(0)
  v_mfma_f32_16x16x32_bf16 v[52:55], v[36:39], v[132:135], 0
  ds_read_b128 v[56:59], v124 offset:4096
  v_mfma_f32_16x16x32_bf16 v[60:63], v[36:39], v[136:139], 0
  v_cvt_pk_bf16_f32 v44, v44, v48
  v_cvt_pk_bf16_f32 v45, v45, v49
  v_cvt_pk_bf16_f32 v46, v46, v50
  v_cvt_pk_bf16_f32 v47, v47, v51
  s_mov_b32 s67, 0
F_kc0:
  s_waitcnt vmcnt(0)
  v_max3_u32 v5, v76, v77, v78
  v_max3_u32 v4, v79, v80, v81
  v_max3_u32 v5, v5, v82, v83
  v_max3_u32 v4, v4, v84, v85
  v_max3_u32 v5, v5, v86, v87
  v_max_u32 v5, v5, v4
  v_cmp_eq_u32 vcc, -1, v5
  s_add_u32 s67, s67, 1
  s_nop 0
  s_cmp_eq_u64 vcc, 0
  s_cbranch_scc1 F_kc0_ok
  s_cmp_gt_u32 s67, 0x3fff
  s_cbranch_scc1 F_kc0_ok
  buffer_load_dwordx4 v[76:79], v157, s[4:7], s52 offen offset:0 sc1
  buffer_load_dwordx4 v[80:83], v157, s[4:7], s52 offen offset:1024 sc1
  buffer_load_dwordx4 v[84:87], v157, s[4:7], s52 offen offset:2048 sc1
  s_branch F_kc0
F_kc0_ok:
  v_mfma_f32_16x16x32_bf16 v[64:67], v[36:39], v[140:143], 0
  s_waitcnt lgkmcnt(0)
  v_mfma_f32_16x16x32_bf16 v[68:71], v[56:59], v[136:139], 0
  v_cvt_pk_bf16_f32 v52, v52, v60
  v_cvt_pk_bf16_f32 v53, v53, v61
  v_cvt_pk_bf16_f32 v54, v54, v62
  v_cvt_pk_bf16_f32 v55, v55, v63
  s_waitcnt vmcnt(2)
  ds_write_b128 v159, v[76:79] offset:0
  s_waitcnt vmcnt(1)
  ds_write_b128 v159, v[80:83] offset:1024
  s_waitcnt vmcnt(0)
  ds_write_b128 v159, v[84:87] offset:2048
  ds_read2_b32 v[72:73], v127 offset0:96 offset1:97
  ds_read2_b32 v[74:75], v127 offset0:98 offset1:99
  ds_read2_b32 v[88:89], v127 offset0:80 offset1:81
  ds_read2_b32 v[90:91], v127 offset0:82 offset1:83
  ds_read2_b32 v[92:93], v127 offset0:144 offset1:145
  ds_read2_b32 v[94:95], v127 offset0:146 offset1:147
  ds_read2_b32 v[96:97], v127 offset0:128 offset1:129
  ds_read2_b32 v[98:99], v127 offset0:130 offset1:131
  v_cvt_pk_bf16_f32 v64, v64, v68
  v_cvt_pk_bf16_f32 v65, v65, v69
  v_cvt_pk_bf16_f32 v66, v66, v70
  v_cvt_pk_bf16_f32 v67, v67, v71
  s_waitcnt lgkmcnt(6)
  v_mfma_f32_16x16x32_bf16 v[16:19], v[32:35], v[72:75], 0
  s_waitcnt lgkmcnt(4)
  v_mfma_f32_16x16x32_bf16 v[20:23], v[32:35], v[88:91], 0
  ds_read2_b32 v[100:101], v126 offset0:128 offset1:129
  ds_read2_b32 v[102:103], v126 offset0:130 offset1:131
  ds_read_b128 v[104:107], v120 offset:12288
  s_waitcnt lgkmcnt(5)
  v_mfma_f32_16x16x32_bf16 v[16:19], v[44:47], v[92:95], v[16:19]
  ds_read2_b32 v[108:109], v126 offset0:112 offset1:113
  ds_read2_b32 v[110:111], v126 offset0:114 offset1:115
  ds_read_b128 v[112:115], v123 offset:10240
  s_waitcnt lgkmcnt(6)
  v_mfma_f32_16x16x32_bf16 v[20:23], v[44:47], v[96:99], v[20:23]
  ds_read2_b32 v[116:117], v126 offset0:96 offset1:97
  ds_read2_b32 v[118:119], v126 offset0:98 offset1:99
  ds_read_b128 v[24:27], v122 offset:10240
  v_mfma_f32_16x16x32_bf16 v[20:23], v[52:55], v[72:75], v[20:23]
  ds_read2_b32 v[28:29], v126 offset0:80 offset1:81
  ds_read2_b32 v[30:31], v126 offset0:82 offset1:83
  ds_read_b128 v[40:43], v121 offset:10240
  v_mfma_f32_16x16x32_bf16 v[20:23], v[64:67], v[92:95], v[20:23]
  ds_read2_b32 v[48:49], v126 offset0:64 offset1:65
  ds_read2_b32 v[50:51], v126 offset0:66 offset1:67
  ds_read_b128 v[36:39], v120 offset:10240
  s_waitcnt lgkmcnt(12)
  v_mfma_f32_16x16x32_bf16 v[20:23], v[100:103], v[104:107], v[20:23]
  ds_read2_b32 v[56:57], v126 offset0:48 offset1:49
  ds_read2_b32 v[58:59], v126 offset0:50 offset1:51
  ds_read_b128 v[60:63], v123 offset:8192
  s_waitcnt lgkmcnt(12)
  v_mfma_f32_16x16x32_bf16 v[20:23], v[108:111], v[112:115], v[20:23]
  ds_read2_b32 v[76:77], v126 offset0:32 offset1:33
  ds_read2_b32 v[78:79], v126 offset0:34 offset1:35
  ds_read_b128 v[80:83], v122 offset:8192
  s_waitcnt lgkmcnt(12)
  v_mfma_f32_16x16x32_bf16 v[20:23], v[116:119], v[24:27], v[20:23]
  ds_read2_b32 v[84:85], v126 offset0:16 offset1:17
  ds_read2_b32 v[86:87], v126 offset0:18 offset1:19
  ds_read_b128 v[68:71], v121 offset:8192
  s_waitcnt lgkmcnt(12)
  v_mfma_f32_16x16x32_bf16 v[20:23], v[28:31], v[40:43], v[20:23]
  ds_read_b128 v[32:35], v120 offset:8192
  s_waitcnt lgkmcnt(10)
  v_mfma_f32_16x16x32_bf16 v[20:23], v[48:51], v[36:39], v[20:23]
  ds_read2_b32 v[88:89], v126 offset0:0 offset1:1
  ds_read2_b32 v[90:91], v126 offset0:2 offset1:3
  s_waitcnt lgkmcnt(9)
  v_mfma_f32_16x16x32_bf16 v[20:23], v[56:59], v[60:63], v[20:23]
  ds_read_b128 v[44:47], v123 offset:6144
  s_waitcnt lgkmcnt(7)
  v_mfma_f32_16x16x32_bf16 v[20:23], v[76:79], v[80:83], v[20:23]
  ds_read2_b32 v[96:97], v125 offset0:112 offset1:113
  ds_read2_b32 v[98:99], v125 offset0:114 offset1:115
  s_waitcnt lgkmcnt(6)
  v_mfma_f32_16x16x32_bf16 v[20:23], v[84:87], v[68:71], v[20:23]
  ds_read_b128 v[52:55], v122 offset:6144
  s_waitcnt lgkmcnt(6)
  v_mfma_f32_16x16x32_bf16 v[16:19], v[100:103], v[32:35], v[16:19]
  ds_read2_b32 v[72:73], v125 offset0:96 offset1:97
  ds_read2_b32 v[74:75], v125 offset0:98 offset1:99
  s_waitcnt lgkmcnt(6)
  v_mfma_f32_16x16x32_bf16 v[20:23], v[88:91], v[32:35], v[20:23]
  ds_read_b128 v[92:95], v121 offset:6144
  s_waitcnt lgkmcnt(6)
  v_mfma_f32_16x16x32_bf16 v[16:19], v[108:111], v[44:47], v[16:19]
  ds_read2_b32 v[64:65], v125 offset0:80 offset1:81
  ds_read2_b32 v[66:67], v125 offset0:82 offset1:83
  s_waitcnt lgkmcnt(6)
  v_mfma_f32_16x16x32_bf16 v[20:23], v[96:99], v[44:47], v[20:23]
  ds_read_b128 v[104:107], v120 offset:6144
  s_waitcnt lgkmcnt(6)
  v_mfma_f32_16x16x32_bf16 v[16:19], v[116:119], v[52:55], v[16:19]
  ds_read2_b32 v[112:113], v125 offset0:64 offset1:65
  ds_read2_b32 v[114:115], v125 offset0:66 offset1:67
  s_waitcnt lgkmcnt(6)
  v_mfma_f32_16x16x32_bf16 v[20:23], v[72:75], v[52:55], v[20:23]
  ds_read_b128 v[24:27], v123 offset:4096
  s_waitcnt lgkmcnt(6)
  v_mfma_f32_16x16x32_bf16 v[16:19], v[28:31], v[92:95], v[16:19]
  ds_read2_b32 v[40:41], v125 offset0:48 offset1:49
  ds_read2_b32 v[42:43], v125 offset0:50 offset1:51
  s_waitcnt lgkmcnt(6)
  v_mfma_f32_16x16x32_bf16 v[20:23], v[64:67], v[92:95], v[20:23]
  ds_read_b128 v[36:39], v122 offset:4096
  s_waitcnt lgkmcnt(6)
  v_mfma_f32_16x16x32_bf16 v[16:19], v[48:51], v[104:107], v[16:19]
  ds_read2_b32 v[60:61], v125 offset0:32 offset1:33
  ds_read2_b32 v[62:63], v125 offset0:34 offset1:35
  s_waitcnt lgkmcnt(6)
  v_mfma_f32_16x16x32_bf16 v[20:23], v[112:115], v[104:107], v[20:23]
  ds_read_b128 v[80:83], v121 offset:4096
  s_waitcnt lgkmcnt(6)
  v_mfma_f32_16x16x32_bf16 v[16:19], v[56:59], v[24:27], v[16:19]
  ds_read2_b32 v[68:69], v125 offset0:16 offset1:17
  ds_read2_b32 v[70:71], v125 offset0:18 offset1:19
  s_waitcnt lgkmcnt(6)
  v_mfma_f32_16x16x32_bf16 v[20:23], v[40:43], v[24:27], v[20:23]
  ds_read_b128 v[32:35], v120 offset:4096
  s_waitcnt lgkmcnt(6)
  v_mfma_f32_16x16x32_bf16 v[16:19], v[76:79], v[36:39], v[16:19]
  s_waitcnt lgkmcnt(4)
  v_mfma_f32_16x16x32_bf16 v[20:23], v[60:63], v[36:39], v[20:23]
  ds_read2_b32 v[44:45], v125 offset0:0 offset1:1
  ds_read2_b32 v[46:47], v125 offset0:2 offset1:3
  s_waitcnt lgkmcnt(5)
  v_mfma_f32_16x16x32_bf16 v[16:19], v[84:87], v[80:83], v[16:19]
  ds_read_b128 v[52:55], v123 offset:2048
  s_waitcnt lgkmcnt(4)
  v_mfma_f32_16x16x32_bf16 v[20:23], v[68:71], v[80:83], v[20:23]
  s_waitcnt lgkmcnt(3)
  v_mfma_f32_16x16x32_bf16 v[12:15], v[100:103], v[32:35], 0
  ds_read_b128 v[92:95], v122 offset:2048
  v_mfma_f32_16x16x32_bf16 v[16:19], v[88:91], v[32:35], v[16:19]
  s_waitcnt lgkmcnt(2)
  v_mfma_f32_16x16x32_bf16 v[20:23], v[44:47], v[32:35], v[20:23]
  ds_read_b128 v[104:107], v121 offset:2048
  s_waitcnt lgkmcnt(2)
  v_mfma_f32_16x16x32_bf16 v[12:15], v[108:111], v[52:55], v[12:15]
  v_mfma_f32_16x16x32_bf16 v[16:19], v[96:99], v[52:55], v[16:19]
  ds_read_b128 v[24:27], v120 offset:2048
  s_waitcnt lgkmcnt(2)
  v_mfma_f32_16x16x32_bf16 v[12:15], v[116:119], v[92:95], v[12:15]
  v_mfma_f32_16x16x32_bf16 v[16:19], v[72:75], v[92:95], v[16:19]
  ds_read_b128 v[36:39], v123 offset:0
  s_waitcnt lgkmcnt(2)
  v_mfma_f32_16x16x32_bf16 v[12:15], v[28:31], v[104:107], v[12:15]
  v_mfma_f32_16x16x32_bf16 v[16:19], v[64:67], v[104:107], v[16:19]
  ds_read_b128 v[80:83], v122 offset:0
  s_waitcnt lgkmcnt(2)
  v_mfma_f32_16x16x32_bf16 v[12:15], v[48:51], v[24:27], v[12:15]
  v_mfma_f32_16x16x32_bf16 v[16:19], v[112:115], v[24:27], v[16:19]
  ds_read_b128 v[32:35], v121 offset:0
  s_waitcnt lgkmcnt(2)
  v_mfma_f32_16x16x32_bf16 v[12:15], v[56:59], v[36:39], v[12:15]
  v_mfma_f32_16x16x32_bf16 v[16:19], v[40:43], v[36:39], v[16:19]
  ds_read_b128 v[52:55], v120 offset:0
  s_waitcnt lgkmcnt(2)
  v_mfma_f32_16x16x32_bf16 v[12:15], v[76:79], v[80:83], v[12:15]
  v_mfma_f32_16x16x32_bf16 v[16:19], v[60:63], v[80:83], v[16:19]
  s_waitcnt lgkmcnt(1)
  v_mfma_f32_16x16x32_bf16 v[12:15], v[84:87], v[32:35], v[12:15]
  ds_read_b128 v[92:95], v167 offset:2048
  v_mfma_f32_16x16x32_bf16 v[16:19], v[68:71], v[32:35], v[16:19]
  s_waitcnt lgkmcnt(1)
  v_mfma_f32_16x16x32_bf16 v[8:11], v[100:103], v[52:55], 0
  ds_read_b128 v[104:107], v166 offset:2048
  v_mfma_f32_16x16x32_bf16 v[12:15], v[88:91], v[52:55], v[12:15]
  v_mfma_f32_16x16x32_bf16 v[16:19], v[44:47], v[52:55], v[16:19]
  ds_read_b128 v[24:27], v165 offset:2048
  s_waitcnt lgkmcnt(2)
  v_mfma_f32_16x16x32_bf16 v[8:11], v[108:111], v[92:95], v[8:11]
  v_mfma_f32_16x16x32_bf16 v[12:15], v[96:99], v[92:95], v[12:15]
  ds_read_b128 v[36:39], v164 offset:0
  s_waitcnt lgkmcnt(2)
  v_mfma_f32_16x16x32_bf16 v[8:11], v[116:119], v[104:107], v[8:11]
  v_mfma_f32_16x16x32_bf16 v[12:15], v[72:75], v[104:107], v[12:15]
  ds_read_b128 v[80:83], v167 offset:0
  s_waitcnt lgkmcnt(2)
  v_mfma_f32_16x16x32_bf16 v[8:11], v[28:31], v[24:27], v[8:11]
  v_mfma_f32_16x16x32_bf16 v[12:15], v[64:67], v[24:27], v[12:15]
  ds_read_b128 v[32:35], v166 offset:0
  s_waitcnt lgkmcnt(2)
  v_mfma_f32_16x16x32_bf16 v[8:11], v[48:51], v[36:39], v[8:11]
  v_mfma_f32_16x16x32_bf16 v[12:15], v[112:115], v[36:39], v[12:15]
  ds_read_b128 v[100:103], v165 offset:0
  s_waitcnt lgkmcnt(2)
  v_mfma_f32_16x16x32_bf16 v[8:11], v[56:59], v[80:83], v[8:11]
  ds_read_b128 v[88:91], v130 offset:0
  ds_read_b128 v[44:47], v130 offset:8192
  v_mfma_f32_16x16x32_bf16 v[12:15], v[40:43], v[80:83], v[12:15]
  s_waitcnt lgkmcnt(3)
  v_mfma_f32_16x16x32_bf16 v[8:11], v[76:79], v[32:35], v[8:11]
  v_mfma_f32_16x16x32_bf16 v[12:15], v[60:63], v[32:35], v[12:15]
  s_waitcnt lgkmcnt(2)
  v_mfma_f32_16x16x32_bf16 v[8:11], v[84:87], v[100:103], v[8:11]
  v_mfma_f32_16x16x32_bf16 v[12:15], v[68:71], v[100:103], v[12:15]
  s_mov_b32 s38, 0x3f80
  s_mov_b32 s39, 0x3f800000
  s_waitcnt lgkmcnt(1)
  v_lshlrev_b32 v132, 16, v88
  v_and_b32 v133, 0xffff0000, v88
  v_lshlrev_b32 v134, 16, v89
  v_and_b32 v135, 0xffff0000, v89
  v_lshlrev_b32 v136, 16, v90
  v_and_b32 v137, 0xffff0000, v90
  v_lshlrev_b32 v138, 16, v91
  v_and_b32 v139, 0xffff0000, v91
  s_waitcnt lgkmcnt(0)
  v_lshlrev_b32 v140, 16, v44
  v_and_b32 v141, 0xffff0000, v44
  v_lshlrev_b32 v142, 16, v45
  v_and_b32 v143, 0xffff0000, v45
  v_lshlrev_b32 v144, 16, v46
  v_and_b32 v145, 0xffff0000, v46
  v_lshlrev_b32 v146, 16, v47
  v_and_b32 v147, 0xffff0000, v47
  v_cvt_pk_bf16_f32 v8, v8, v9
  v_cvt_pk_bf16_f32 v9, v10, v11
  ds_write_b64 v128, v[8:9] offset:0
  v_cvt_pk_bf16_f32 v12, v12, v13
  v_cvt_pk_bf16_f32 v13, v14, v15
  ds_write_b64 v128, v[12:13] offset:512
  v_cvt_pk_bf16_f32 v16, v16, v17
  v_cvt_pk_bf16_f32 v17, v18, v19
  ds_write_b64 v128, v[16:17] offset:1024
  v_cvt_pk_bf16_f32 v20, v20, v21
  v_cvt_pk_bf16_f32 v21, v22, v23
  ds_write_b64 v128, v[20:21] offset:1536
  s_mov_b64 exec, 1
  ds_add_u32 v162, v163 offset:8
  s_mov_b64 exec, -1
  s_mov_b32 s67, 0
F_fb0:
  ds_read_b32 v4, v162 offset:8
  s_add_u32 s67, s67, 1
  s_waitcnt lgkmcnt(0)
  v_readfirstlane_b32 s66, v4
  s_cmp_ge_u32 s66, 8
  s_cbranch_scc1 F_fb0_ok
  s_cmp_lt_u32 s67, 0xfffff
  s_cbranch_scc1 F_fb0
F_fb0_ok:
  ds_read_b64_tr_b16 v[80:81], v129 offset:0
  ds_read_b64_tr_b16 v[82:83], v129 offset:8448
  ds_read_b64_tr_b16 v[84:85], v129 offset:1024
  ds_read_b64_tr_b16 v[86:87], v129 offset:9472
  s_waitcnt lgkmcnt(3)
  v_dot2c_f32_bf16 v132, s38, v80
  v_dot2c_f32_bf16 v133, s39, v80
  v_dot2c_f32_bf16 v134, s38, v81
  v_dot2c_f32_bf16 v135, s39, v81
  s_waitcnt lgkmcnt(2)
  v_dot2c_f32_bf16 v136, s38, v82
  v_dot2c_f32_bf16 v137, s39, v82
  v_dot2c_f32_bf16 v138, s38, v83
  v_dot2c_f32_bf16 v139, s39, v83
  v_cvt_pk_bf16_f32 v80, v132, v133
  v_cvt_pk_bf16_f32 v81, v134, v135
  v_cvt_pk_bf16_f32 v82, v136, v137
  v_cvt_pk_bf16_f32 v83, v138, v139
  buffer_store_dwordx4 v[80:83], v131, s[4:7], s54 offen sc1
  s_waitcnt lgkmcnt(1)
  v_dot2c_f32_bf16 v140, s38, v84
  v_dot2c_f32_bf16 v141, s39, v84
  v_dot2c_f32_bf16 v142, s38, v85
  v_dot2c_f32_bf16 v143, s39, v85
  s_waitcnt lgkmcnt(0)
  v_dot2c_f32_bf16 v144, s38, v86
  v_dot2c_f32_bf16 v145, s39, v86
  v_dot2c_f32_bf16 v146, s38, v87
  v_dot2c_f32_bf16 v147, s39, v87
  v_cvt_pk_bf16_f32 v84, v140, v141
  v_cvt_pk_bf16_f32 v85, v142, v143
  v_cvt_pk_bf16_f32 v86, v144, v145
  v_cvt_pk_bf16_f32 v87, v146, v147
  buffer_store_dwordx4 v[84:87], v131, s[4:7], s55 offen sc1
  s_endpgm
B_t1:
  ds_read_b128 v[16:19], v120 offset:0
  ds_read_b128 v[20:23], v124 offset:0
  s_waitcnt lgkmcnt(1)
  v_mfma_f32_16x16x32_bf16 v[24:27], v[16:19], v[132:135], 0
  v_mfma_f32_16x16x32_bf16 v[28:31], v[16:19], v[136:139], 0
  v_mfma_f32_16x16x32_bf16 v[32:35], v[16:19], v[140:143], 0
  s_waitcnt lgkmcnt(0)
  v_mfma_f32_16x16x32_bf16 v[36:39], v[20:23], v[136:139], 0
  ds_read_b128 v[40:43], v120 offset:4096
  s_nop 3
  v_cvt_pk_bf16_f32 v24, v24, v28
  v_cvt_pk_bf16_f32 v25, v25, v29
  v_cvt_pk_bf16_f32 v26, v26, v30
  v_cvt_pk_bf16_f32 v27, v27, v31
  v_mfma_f32_16x16x32_bf16 v[44:47], v[16:19], v[144:147], 0
  v_mfma_f32_16x16x32_bf16 v[48:51], v[20:23], v[148:151], 0
  v_cvt_pk_bf16_f32 v32, v32, v36
  v_cvt_pk_bf16_f32 v33, v33, v37
  v_cvt_pk_bf16_f32 v34, v34, v38
  v_cvt_pk_bf16_f32 v35, v35, v39
  s_waitcnt lgkmcnt(0)
  v_mfma_f32_16x16x32_bf16 v[52:55], v[40:43], v[132:135], 0
  ds_read_b128 v[56:59], v124 offset:4096
  v_mfma_f32_16x16x32_bf16 v[60:63], v[40:43], v[136:139], 0
  s_mov_b32 s67, 0
F_kc1:
  s_waitcnt vmcnt(0)
  v_max3_u32 v5, v76, v77, v78
  v_max3_u32 v4, v79, v80, v81
  v_max3_u32 v5, v5, v82, v83
  v_max3_u32 v4, v4, v84, v85
  v_max3_u32 v5, v5, v86, v87
  v_max_u32 v5, v5, v4
  v_cmp_eq_u32 vcc, -1, v5
  s_add_u32 s67, s67, 1
  s_nop 0
  s_cmp_eq_u64 vcc, 0
  s_cbranch_scc1 F_kc1_ok
  s_cmp_gt_u32 s67, 0x3fff
  s_cbranch_scc1 F_kc1_ok
  buffer_load_dwordx4 v[76:79], v157, s[4:7], s52 offen offset:0 sc1
  buffer_load_dwordx4 v[80:83], v157, s[4:7], s52 offen offset:1024 sc1
  buffer_load_dwordx4 v[84:87], v157, s[4:7], s52 offen offset:2048 sc1
  s_branch F_kc1
F_kc1_ok:
  v_cvt_pk_bf16_f32 v44, v44, v48
  v_cvt_pk_bf16_f32 v45, v45, v49
  v_cvt_pk_bf16_f32 v46, v46, v50
  v_cvt_pk_bf16_f32 v47, v47, v51
  v_mfma_f32_16x16x32_bf16 v[64:67], v[40:43], v[140:143], 0
  s_waitcnt lgkmcnt(0)
  v_mfma_f32_16x16x32_bf16 v[68:71], v[56:59], v[136:139], 0
  ds_read_b128 v[72:75], v120 offset:8192
  v_cvt_pk_bf16_f32 v52, v52, v60
  v_cvt_pk_bf16_f32 v53, v53, v61
  v_cvt_pk_bf16_f32 v54, v54, v62
  v_cvt_pk_bf16_f32 v55, v55, v63
  v_mfma_f32_16x16x32_bf16 v[88:91], v[40:43], v[144:147], 0
  v_mfma_f32_16x16x32_bf16 v[92:95], v[56:59], v[148:151], 0
  s_nop 0
  v_cvt_pk_bf16_f32 v64, v64, v68
  v_cvt_pk_bf16_f32 v65, v65, v69
  v_cvt_pk_bf16_f32 v66, v66, v70
  v_cvt_pk_bf16_f32 v67, v67, v71
  ds_read_b128 v[96:99], v124 offset:8192
  s_waitcnt lgkmcnt(1)
  v_mfma_f32_16x16x32_bf16 v[100:103], v[72:75], v[132:135], 0
  v_mfma_f32_16x16x32_bf16 v[104:107], v[72:75], v[136:139], 0
  ds_read_b128 v[108:111], v120 offset:12288
  v_cvt_pk_bf16_f32 v88, v88, v92
  v_cvt_pk_bf16_f32 v89, v89, v93
  v_cvt_pk_bf16_f32 v90, v90, v94
  v_cvt_pk_bf16_f32 v91, v91, v95
  v_mfma_f32_16x16x32_bf16 v[112:115], v[72:75], v[140:143], 0
  s_waitcnt lgkmcnt(1)
  v_mfma_f32_16x16x32_bf16 v[116:119], v[96:99], v[136:139], 0
  v_cvt_pk_bf16_f32 v100, v100, v104
  v_cvt_pk_bf16_f32 v101, v101, v105
  v_cvt_pk_bf16_f32 v102, v102, v106
  v_cvt_pk_bf16_f32 v103, v103, v107
  ds_read_b128 v[164:167], v124 offset:12288
  s_waitcnt lgkmcnt(1)
  v_mfma_f32_16x16x32_bf16 v[28:31], v[108:111], v[132:135], 0
  v_mfma_f32_16x16x32_bf16 v[16:19], v[108:111], v[136:139], 0
  v_cvt_pk_bf16_f32 v112, v112, v116
  v_cvt_pk_bf16_f32 v113, v113, v117
  v_cvt_pk_bf16_f32 v114, v114, v118
  v_cvt_pk_bf16_f32 v115, v115, v119
  v_mfma_f32_16x16x32_bf16 v[20:23], v[108:111], v[140:143], 0
  s_waitcnt lgkmcnt(0)
  v_mfma_f32_16x16x32_bf16 v[36:39], v[164:167], v[136:139], 0
  s_nop 0
  v_cvt_pk_bf16_f32 v28, v28, v16
  v_cvt_pk_bf16_f32 v29, v29, v17
  v_cvt_pk_bf16_f32 v30, v30, v18
  v_cvt_pk_bf16_f32 v31, v31, v19
  s_waitcnt vmcnt(2)
  ds_write_b128 v159, v[76:79] offset:0
  s_waitcnt vmcnt(1)
  ds_write_b128 v159, v[80:83] offset:1024
  s_waitcnt vmcnt(0)
  ds_write_b128 v159, v[84:87] offset:2048
  v_mov_b32 v4, s53
  ds_read_b32 v4, v4 offset:1824
  ds_read2_b32 v[48:49], v127 offset0:64 offset1:65
  ds_read2_b32 v[50:51], v127 offset0:66 offset1:67
  ds_read2_b32 v[60:61], v127 offset0:112 offset1:113
  ds_read2_b32 v[62:63], v127 offset0:114 offset1:115
  ds_read2_b32 v[40:41], v127 offset0:48 offset1:49
  ds_read2_b32 v[42:43], v127 offset0:50 offset1:51
  ds_read2_b32 v[56:57], v127 offset0:32 offset1:33
  ds_read2_b32 v[58:59], v127 offset0:34 offset1:35
  v_cvt_pk_bf16_f32 v20, v20, v36
  v_cvt_pk_bf16_f32 v21, v21, v37
  v_cvt_pk_bf16_f32 v22, v22, v38
  v_cvt_pk_bf16_f32 v23, v23, v39
  ds_read2_b32 v[68:69], v127 offset0:80 offset1:81
  ds_read2_b32 v[70:71], v127 offset0:82 offset1:83
  s_waitcnt lgkmcnt(8)
  v_mfma_f32_16x16x32_bf16 v[8:11], v[24:27], v[48:51], 0
  s_waitcnt lgkmcnt(6)
  v_mfma_f32_16x16x32_bf16 v[8:11], v[32:35], v[60:63], v[8:11]
  ds_read2_b32 v[92:93], v127 offset0:128 offset1:129
  ds_read2_b32 v[94:95], v127 offset0:130 offset1:131
  s_waitcnt lgkmcnt(6)
  v_mfma_f32_16x16x32_bf16 v[8:11], v[44:47], v[40:43], v[8:11]
  s_waitcnt lgkmcnt(4)
  v_mfma_f32_16x16x32_bf16 v[12:15], v[44:47], v[56:59], 0
  s_waitcnt lgkmcnt(2)
  v_mfma_f32_16x16x32_bf16 v[8:11], v[52:55], v[68:71], v[8:11]
  ds_read2_b32 v[72:73], v127 offset0:96 offset1:97
  ds_read2_b32 v[74:75], v127 offset0:98 offset1:99
  v_mfma_f32_16x16x32_bf16 v[12:15], v[52:55], v[48:51], v[12:15]
  s_waitcnt lgkmcnt(2)
  v_mfma_f32_16x16x32_bf16 v[8:11], v[64:67], v[92:95], v[8:11]
  ds_read2_b32 v[96:97], v127 offset0:144 offset1:145
  ds_read2_b32 v[98:99], v127 offset0:146 offset1:147
  v_mfma_f32_16x16x32_bf16 v[12:15], v[64:67], v[60:63], v[12:15]
  v_mfma_f32_16x16x32_bf16 v[12:15], v[88:91], v[40:43], v[12:15]
  s_waitcnt lgkmcnt(2)
  v_mfma_f32_16x16x32_bf16 v[8:11], v[100:103], v[72:75], v[8:11]
  v_mfma_f32_16x16x32_bf16 v[12:15], v[100:103], v[68:71], v[12:15]
  ds_read_b128 v[104:107], v120 offset:0
  s_waitcnt lgkmcnt(1)
  v_mfma_f32_16x16x32_bf16 v[8:11], v[112:115], v[96:99], v[8:11]
  ds_read_b128 v[116:119], v120 offset:4096
  v_mfma_f32_16x16x32_bf16 v[12:15], v[112:115], v[92:95], v[12:15]
  ds_read2_b32 v[108:109], v126 offset0:128 offset1:129
  ds_read2_b32 v[110:111], v126 offset0:130 offset1:131
  ds_read_b128 v[164:167], v120 offset:20480
  v_mfma_f32_16x16x32_bf16 v[12:15], v[28:31], v[72:75], v[12:15]
  ds_read_b128 v[16:19], v120 offset:16384
  v_mfma_f32_16x16x32_bf16 v[12:15], v[20:23], v[96:99], v[12:15]
  ds_read2_b32 v[76:77], v126 offset0:112 offset1:113
  ds_read2_b32 v[78:79], v126 offset0:114 offset1:115
  ds_read_b128 v[80:83], v123 offset:18432
  v_and_b32 v152, v152, v4
  v_and_b32 v153, v153, v4
  v_and_b32 v154, v154, v4
  v_and_b32 v155, v155, v4
  s_waitcnt lgkmcnt(8)
  s_nop 0
  v_mfma_f32_16x16x32_bf16 v[8:11], v[152:155], v[104:107], v[8:11]
  ds_read_b128 v[84:87], v123 offset:14336
  s_waitcnt lgkmcnt(8)
  v_mfma_f32_16x16x32_bf16 v[12:15], v[152:155], v[116:119], v[12:15]
  ds_read2_b32 v[36:37], v126 offset0:96 offset1:97
  ds_read2_b32 v[38:39], v126 offset0:98 offset1:99
  ds_read_b128 v[24:27], v122 offset:18432
  s_waitcnt lgkmcnt(8)
  v_mfma_f32_16x16x32_bf16 v[12:15], v[108:111], v[164:167], v[12:15]
  ds_read_b128 v[32:35], v122 offset:14336
  s_waitcnt lgkmcnt(8)
  v_mfma_f32_16x16x32_bf16 v[8:11], v[108:111], v[16:19], v[8:11]
  ds_read2_b32 v[44:45], v126 offset0:80 offset1:81
  ds_read2_b32 v[46:47], v126 offset0:82 offset1:83
  ds_read_b128 v[56:59], v121 offset:18432
  s_waitcnt lgkmcnt(8)
  v_mfma_f32_16x16x32_bf16 v[12:15], v[76:79], v[80:83], v[12:15]
  ds_read_b128 v[52:55], v121 offset:14336
  s_waitcnt lgkmcnt(8)
  v_mfma_f32_16x16x32_bf16 v[8:11], v[76:79], v[84:87], v[8:11]
  ds_read2_b32 v[48:49], v126 offset0:64 offset1:65
  ds_read2_b32 v[50:51], v126 offset0:66 offset1:67
  ds_read_b128 v[64:67], v120 offset:18432
  s_waitcnt lgkmcnt(8)
  v_mfma_f32_16x16x32_bf16 v[12:15], v[36:39], v[24:27], v[12:15]
  ds_read_b128 v[60:63], v120 offset:14336
  s_waitcnt lgkmcnt(8)
  v_mfma_f32_16x16x32_bf16 v[8:11], v[36:39], v[32:35], v[8:11]
  ds_read2_b32 v[88:89], v126 offset0:48 offset1:49
  ds_read2_b32 v[90:91], v126 offset0:50 offset1:51
  ds_read_b128 v[40:43], v123 offset:16384
  s_waitcnt lgkmcnt(8)
  v_mfma_f32_16x16x32_bf16 v[12:15], v[44:47], v[56:59], v[12:15]
  ds_read_b128 v[100:103], v123 offset:12288
  s_waitcnt lgkmcnt(8)
  v_mfma_f32_16x16x32_bf16 v[8:11], v[44:47], v[52:55], v[8:11]
  ds_read2_b32 v[68:69], v126 offset0:32 offset1:33
  ds_read2_b32 v[70:71], v126 offset0:34 offset1:35
  ds_read_b128 v[112:115], v122 offset:16384
  s_waitcnt lgkmcnt(8)
  v_mfma_f32_16x16x32_bf16 v[12:15], v[48:51], v[64:67], v[12:15]
  ds_read_b128 v[92:95], v122 offset:12288
  s_waitcnt lgkmcnt(8)
  v_mfma_f32_16x16x32_bf16 v[8:11], v[48:51], v[60:63], v[8:11]
  ds_read2_b32 v[28:29], v126 offset0:16 offset1:17
  ds_read2_b32 v[30:31], v126 offset0:18 offset1:19
  ds_read_b128 v[72:75], v121 offset:16384
  s_waitcnt lgkmcnt(8)
  v_mfma_f32_16x16x32_bf16 v[12:15], v[88:91], v[40:43], v[12:15]
  ds_read_b128 v[20:23], v121 offset:12288
  s_waitcnt lgkmcnt(8)
  v_mfma_f32_16x16x32_bf16 v[8:11], v[88:91], v[100:103], v[8:11]
  ds_read2_b32 v[96:97], v126 offset0:0 offset1:1
  ds_read2_b32 v[98:99], v126 offset0:2 offset1:3
  s_waitcnt lgkmcnt(7)
  v_mfma_f32_16x16x32_bf16 v[12:15], v[68:71], v[112:115], v[12:15]
  ds_read_b128 v[104:107], v120 offset:12288
  s_waitcnt lgkmcnt(7)
  v_mfma_f32_16x16x32_bf16 v[8:11], v[68:71], v[92:95], v[8:11]
  ds_read2_b32 v[116:117], v125 offset0:112 offset1:113
  ds_read2_b32 v[118:119], v125 offset0:114 offset1:115
  s_waitcnt lgkmcnt(6)
  v_mfma_f32_16x16x32_bf16 v[12:15], v[28:31], v[72:75], v[12:15]
  ds_read_b128 v[164:167], v123 offset:10240
  s_waitcnt lgkmcnt(6)
  v_mfma_f32_16x16x32_bf16 v[8:11], v[28:31], v[20:23], v[8:11]
  ds_read2_b32 v[108:109], v125 offset0:96 offset1:97
  ds_read2_b32 v[110:111], v125 offset0:98 offset1:99
  s_waitcnt lgkmcnt(6)
  v_mfma_f32_16x16x32_bf16 v[12:15], v[96:99], v[16:19], v[12:15]
  ds_read_b128 v[80:83], v122 offset:10240
  s_waitcnt lgkmcnt(6)
  v_mfma_f32_16x16x32_bf16 v[8:11], v[96:99], v[104:107], v[8:11]
  ds_read2_b32 v[76:77], v125 offset0:80 offset1:81
  ds_read2_b32 v[78:79], v125 offset0:82 offset1:83
  s_waitcnt lgkmcnt(6)
  v_mfma_f32_16x16x32_bf16 v[12:15], v[116:119], v[84:87], v[12:15]
  ds_read_b128 v[24:27], v121 offset:10240
  s_waitcnt lgkmcnt(6)
  v_mfma_f32_16x16x32_bf16 v[8:11], v[116:119], v[164:167], v[8:11]
  ds_read2_b32 v[36:37], v125 offset0:64 offset1:65
  ds_read2_b32 v[38:39], v125 offset0:66 offset1:67
  s_waitcnt lgkmcnt(6)
  v_mfma_f32_16x16x32_bf16 v[12:15], v[108:111], v[32:35], v[12:15]
  ds_read_b128 v[56:59], v120 offset:10240
  s_waitcnt lgkmcnt(6)
  v_mfma_f32_16x16x32_bf16 v[8:11], v[108:111], v[80:83], v[8:11]
  ds_read2_b32 v[44:45], v125 offset0:48 offset1:49
  ds_read2_b32 v[46:47], v125 offset0:50 offset1:51
  s_waitcnt lgkmcnt(6)
  v_mfma_f32_16x16x32_bf16 v[12:15], v[76:79], v[52:55], v[12:15]
  ds_read_b128 v[64:67], v123 offset:8192
  s_waitcnt lgkmcnt(6)
  v_mfma_f32_16x16x32_bf16 v[8:11], v[76:79], v[24:27], v[8:11]
  ds_read2_b32 v[48:49], v125 offset0:32 offset1:33
  ds_read2_b32 v[50:51], v125 offset0:34 offset1:35
  s_waitcnt lgkmcnt(6)
  v_mfma_f32_16x16x32_bf16 v[12:15], v[36:39], v[60:63], v[12:15]
  ds_read_b128 v[40:43], v122 offset:8192
  s_waitcnt lgkmcnt(6)
  v_mfma_f32_16x16x32_bf16 v[8:11], v[36:39], v[56:59], v[8:11]
  ds_read2_b32 v[88:89], v125 offset0:16 offset1:17
  ds_read2_b32 v[90:91], v125 offset0:18 offset1:19
  s_waitcnt lgkmcnt(6)
  v_mfma_f32_16x16x32_bf16 v[12:15], v[44:47], v[100:103], v[12:15]
  ds_read_b128 v[112:115], v121 offset:8192
  s_waitcnt lgkmcnt(6)
  v_mfma_f32_16x16x32_bf16 v[8:11], v[44:47], v[64:67], v[8:11]
  ds_read2_b32 v[68:69], v125 offset0:0 offset1:1
  ds_read2_b32 v[70:71], v125 offset0:2 offset1:3
  s_waitcnt lgkmcnt(6)
  v_mfma_f32_16x16x32_bf16 v[12:15], v[48:51], v[92:95], v[12:15]
  ds_read_b128 v[72:75], v130 offset:0
  ds_read_b128 v[28:31], v120 offset:8192
  s_waitcnt lgkmcnt(7)
  v_mfma_f32_16x16x32_bf16 v[8:11], v[48:51], v[40:43], v[8:11]
  s_waitcnt lgkmcnt(5)
  v_mfma_f32_16x16x32_bf16 v[12:15], v[88:91], v[20:23], v[12:15]
  s_waitcnt lgkmcnt(4)
  v_mfma_f32_16x16x32_bf16 v[8:11], v[88:91], v[112:115], v[8:11]
  s_waitcnt lgkmcnt(2)
  v_mfma_f32_16x16x32_bf16 v[12:15], v[68:71], v[104:107], v[12:15]
  s_waitcnt lgkmcnt(0)
  v_mfma_f32_16x16x32_bf16 v[8:11], v[68:71], v[28:31], v[8:11]
  s_mov_b32 s38, 0x3f80
  s_mov_b32 s39, 0x3f800000
  v_lshlrev_b32 v132, 16, v72
  v_and_b32 v133, 0xffff0000, v72
  v_lshlrev_b32 v134, 16, v73
  v_and_b32 v135, 0xffff0000, v73
  v_lshlrev_b32 v136, 16, v74
  v_and_b32 v137, 0xffff0000, v74
  v_lshlrev_b32 v138, 16, v75
  v_and_b32 v139, 0xffff0000, v75
  v_cvt_pk_bf16_f32 v8, v8, v9
  v_cvt_pk_bf16_f32 v9, v10, v11
  ds_write_b64 v128, v[8:9] offset:0
  v_cvt_pk_bf16_f32 v12, v12, v13
  v_cvt_pk_bf16_f32 v13, v14, v15
  ds_write_b64 v128, v[12:13] offset:512
  s_mov_b64 exec, 1
  ds_add_u32 v162, v163 offset:8
  s_mov_b64 exec, -1
  s_mov_b32 s67, 0
F_fb1:
  ds_read_b32 v4, v162 offset:8
  s_add_u32 s67, s67, 1
  s_waitcnt lgkmcnt(0)
  v_readfirstlane_b32 s66, v4
  s_cmp_ge_u32 s66, 8
  s_cbranch_scc1 F_fb1_ok
  s_cmp_lt_u32 s67, 0xfffff
  s_cbranch_scc1 F_fb1
F_fb1_ok:
  ds_read_b64_tr_b16 v[80:81], v129 offset:0
  ds_read_b64_tr_b16 v[82:83], v129 offset:8448
  s_waitcnt lgkmcnt(1)
  v_dot2c_f32_bf16 v132, s38, v80
  v_dot2c_f32_bf16 v133, s39, v80
  v_dot2c_f32_bf16 v134, s38, v81
  v_dot2c_f32_bf16 v135, s39, v81
  s_waitcnt lgkmcnt(0)
  v_dot2c_f32_bf16 v136, s38, v82
  v_dot2c_f32_bf16 v137, s39, v82
  v_dot2c_f32_bf16 v138, s38, v83
  v_dot2c_f32_bf16 v139, s39, v83
  v_cvt_pk_bf16_f32 v80, v132, v133
  v_cvt_pk_bf16_f32 v81, v134, v135
  v_cvt_pk_bf16_f32 v82, v136, v137
  v_cvt_pk_bf16_f32 v83, v138, v139
  buffer_store_dwordx4 v[80:83], v131, s[4:7], s54 offen sc1
  s_endpgm
B_t2:
  ds_read_b128 v[16:19], v120 offset:0
  ds_read_b128 v[20:23], v124 offset:0
  ds_read_b128 v[24:27], v120 offset:4096
  ds_read_b128 v[28:31], v124 offset:4096
  s_waitcnt lgkmcnt(3)
  v_mfma_f32_16x16x32_bf16 v[32:35], v[16:19], v[144:147], 0
  ds_read_b128 v[36:39], v120 offset:8192
  s_waitcnt lgkmcnt(3)
  v_mfma_f32_16x16x32_bf16 v[40:43], v[20:23], v[148:151], 0
  s_waitcnt lgkmcnt(2)
  v_mfma_f32_16x16x32_bf16 v[44:47], v[24:27], v[144:147], 0
  s_waitcnt lgkmcnt(1)
  v_mfma_f32_16x16x32_bf16 v[48:51], v[28:31], v[148:151], 0
  s_nop 3
  v_cvt_pk_bf16_f32 v32, v32, v40
  v_cvt_pk_bf16_f32 v33, v33, v41
  v_cvt_pk_bf16_f32 v34, v34, v42
  v_cvt_pk_bf16_f32 v35, v35, v43
  ds_read_b128 v[52:55], v124 offset:8192
  s_waitcnt lgkmcnt(1)
  v_mfma_f32_16x16x32_bf16 v[56:59], v[36:39], v[132:135], 0
  v_mfma_f32_16x16x32_bf16 v[60:63], v[36:39], v[136:139], 0
  v_cvt_pk_bf16_f32 v44, v44, v48
  v_cvt_pk_bf16_f32 v45, v45, v49
  v_cvt_pk_bf16_f32 v46, v46, v50
  v_cvt_pk_bf16_f32 v47, v47, v51
  v_mfma_f32_16x16x32_bf16 v[64:67], v[36:39], v[140:143], 0
  s_waitcnt lgkmcnt(0)
  v_mfma_f32_16x16x32_bf16 v[68:71], v[52:55], v[136:139], 0
  s_mov_b32 s67, 0
F_kc2:
  s_waitcnt vmcnt(0)
  v_max3_u32 v5, v76, v77, v78
  v_max3_u32 v4, v79, v80, v81
  v_max3_u32 v5, v5, v82, v83
  v_max3_u32 v4, v4, v84, v85
  v_max3_u32 v5, v5, v86, v87
  v_max_u32 v5, v5, v4
  v_cmp_eq_u32 vcc, -1, v5
  s_add_u32 s67, s67, 1
  s_nop 0
  s_cmp_eq_u64 vcc, 0
  s_cbranch_scc1 F_kc2_ok
  s_cmp_gt_u32 s67, 0x3fff
  s_cbranch_scc1 F_kc2_ok
  buffer_load_dwordx4 v[76:79], v157, s[4:7], s52 offen offset:0 sc1
  buffer_load_dwordx4 v[80:83], v157, s[4:7], s52 offen offset:1024 sc1
  buffer_load_dwordx4 v[84:87], v157, s[4:7], s52 offen offset:2048 sc1
  s_branch F_kc2
F_kc2_ok:
  ds_read_b128 v[72:75], v120 offset:12288
  v_cvt_pk_bf16_f32 v56, v56, v60
  v_cvt_pk_bf16_f32 v57, v57, v61
  v_cvt_pk_bf16_f32 v58, v58, v62
  v_cvt_pk_bf16_f32 v59, v59, v63
  v_mfma_f32_16x16x32_bf16 v[88:91], v[36:39], v[144:147], 0
  v_mfma_f32_16x16x32_bf16 v[92:95], v[52:55], v[148:151], 0
  v_cvt_pk_bf16_f32 v64, v64, v68
  v_cvt_pk_bf16_f32 v65, v65, v69
  v_cvt_pk_bf16_f32 v66, v66, v70
  v_cvt_pk_bf16_f32 v67, v67, v71
  ds_read_b128 v[96:99], v124 offset:12288
  s_waitcnt lgkmcnt(1)
  v_mfma_f32_16x16x32_bf16 v[100:103], v[72:75], v[132:135], 0
  v_mfma_f32_16x16x32_bf16 v[104:107], v[72:75], v[136:139], 0
  v_cvt_pk_bf16_f32 v88, v88, v92
  v_cvt_pk_bf16_f32 v89, v89, v93
  v_cvt_pk_bf16_f32 v90, v90, v94
  v_cvt_pk_bf16_f32 v91, v91, v95
  v_mfma_f32_16x16x32_bf16 v[108:111], v[72:75], v[140:143], 0
  s_waitcnt lgkmcnt(0)
  v_mfma_f32_16x16x32_bf16 v[112:115], v[96:99], v[136:139], 0
  ds_read_b128 v[116:119], v120 offset:16384
  v_cvt_pk_bf16_f32 v100, v100, v104
  v_cvt_pk_bf16_f32 v101, v101, v105
  v_cvt_pk_bf16_f32 v102, v102, v106
  v_cvt_pk_bf16_f32 v103, v103, v107
  v_mfma_f32_16x16x32_bf16 v[164:167], v[72:75], v[144:147], 0
  v_mfma_f32_16x16x32_bf16 v[16:19], v[96:99], v[148:151], 0
  s_nop 0
  v_cvt_pk_bf16_f32 v108, v108, v112
  v_cvt_pk_bf16_f32 v109, v109, v113
  v_cvt_pk_bf16_f32 v110, v110, v114
  v_cvt_pk_bf16_f32 v111, v111, v115
  ds_read_b128 v[20:23], v124 offset:16384
  s_waitcnt lgkmcnt(1)
  v_mfma_f32_16x16x32_bf16 v[24:27], v[116:119], v[132:135], 0
  v_mfma_f32_16x16x32_bf16 v[28:31], v[116:119], v[136:139], 0
  ds_read_b128 v[40:43], v120 offset:20480
  v_cvt_pk_bf16_f32 v164, v164, v16
  v_cvt_pk_bf16_f32 v165, v165, v17
  v_cvt_pk_bf16_f32 v166, v166, v18
  v_cvt_pk_bf16_f32 v167, v167, v19
  v_mfma_f32_16x16x32_bf16 v[48:51], v[116:119], v[140:143], 0
  s_waitcnt lgkmcnt(1)
  v_mfma_f32_16x16x32_bf16 v[60:63], v[20:23], v[136:139], 0
  v_cvt_pk_bf16_f32 v24, v24, v28
  v_cvt_pk_bf16_f32 v25, v25, v29
  v_cvt_pk_bf16_f32 v26, v26, v30
  v_cvt_pk_bf16_f32 v27, v27, v31
  ds_read_b128 v[36:39], v124 offset:20480
  s_waitcnt lgkmcnt(1)
  v_mfma_f32_16x16x32_bf16 v[52:55], v[40:43], v[132:135], 0
  v_mfma_f32_16x16x32_bf16 v[68:71], v[40:43], v[136:139], 0
  v_cvt_pk_bf16_f32 v48, v48, v60
  v_cvt_pk_bf16_f32 v49, v49, v61
  v_cvt_pk_bf16_f32 v50, v50, v62
  v_cvt_pk_bf16_f32 v51, v51, v63
  v_mfma_f32_16x16x32_bf16 v[92:95], v[40:43], v[140:143], 0
  s_waitcnt lgkmcnt(0)
  v_mfma_f32_16x16x32_bf16 v[104:107], v[36:39], v[136:139], 0
  s_nop 0
  v_cvt_pk_bf16_f32 v52, v52, v68
  v_cvt_pk_bf16_f32 v53, v53, v69
  v_cvt_pk_bf16_f32 v54, v54, v70
  v_cvt_pk_bf16_f32 v55, v55, v71
  s_waitcnt vmcnt(2)
  ds_write_b128 v159, v[76:79] offset:0
  s_waitcnt vmcnt(1)
  ds_write_b128 v159, v[80:83] offset:1024
  s_waitcnt vmcnt(0)
  ds_write_b128 v159, v[84:87] offset:2048
  v_mov_b32 v4, s53
  ds_read_b32 v4, v4 offset:1824
  ds_read2_b32 v[72:73], v127 offset0:16 offset1:17
  ds_read2_b32 v[74:75], v127 offset0:18 offset1:19
  ds_read2_b32 v[96:97], v127 offset0:0 offset1:1
  ds_read2_b32 v[98:99], v127 offset0:2 offset1:3
  ds_read2_b32 v[112:113], v127 offset0:32 offset1:33
  ds_read2_b32 v[114:115], v127 offset0:34 offset1:35
  v_cvt_pk_bf16_f32 v92, v92, v104
  v_cvt_pk_bf16_f32 v93, v93, v105
  v_cvt_pk_bf16_f32 v94, v94, v106
  v_cvt_pk_bf16_f32 v95, v95, v107
  ds_read2_b32 v[16:17], v127 offset0:64 offset1:65
  ds_read2_b32 v[18:19], v127 offset0:66 offset1:67
  s_waitcnt lgkmcnt(6)
  v_mfma_f32_16x16x32_bf16 v[8:11], v[32:35], v[72:75], 0
  ds_read2_b32 v[116:117], v127 offset0:112 offset1:113
  ds_read2_b32 v[118:119], v127 offset0:114 offset1:115
  s_waitcnt lgkmcnt(6)
  v_mfma_f32_16x16x32_bf16 v[12:15], v[32:35], v[96:99], 0
  ds_read2_b32 v[20:21], v127 offset0:48 offset1:49
  ds_read2_b32 v[22:23], v127 offset0:50 offset1:51
  s_waitcnt lgkmcnt(6)
  v_mfma_f32_16x16x32_bf16 v[8:11], v[44:47], v[112:115], v[8:11]
  v_mfma_f32_16x16x32_bf16 v[12:15], v[44:47], v[72:75], v[12:15]
  ds_read2_b32 v[28:29], v127 offset0:80 offset1:81
  ds_read2_b32 v[30:31], v127 offset0:82 offset1:83
  s_waitcnt lgkmcnt(6)
  v_mfma_f32_16x16x32_bf16 v[8:11], v[56:59], v[16:19], v[8:11]
  s_waitcnt lgkmcnt(4)
  v_mfma_f32_16x16x32_bf16 v[8:11], v[64:67], v[116:119], v[8:11]
  ds_read2_b32 v[60:61], v127 offset0:128 offset1:129
  ds_read2_b32 v[62:63], v127 offset0:130 offset1:131
  s_waitcnt lgkmcnt(4)
  v_mfma_f32_16x16x32_bf16 v[8:11], v[88:91], v[20:23], v[8:11]
  v_mfma_f32_16x16x32_bf16 v[12:15], v[88:91], v[112:115], v[12:15]
  s_waitcnt lgkmcnt(2)
  v_mfma_f32_16x16x32_bf16 v[8:11], v[100:103], v[28:31], v[8:11]
  ds_read2_b32 v[40:41], v127 offset0:96 offset1:97
  ds_read2_b32 v[42:43], v127 offset0:98 offset1:99
  v_mfma_f32_16x16x32_bf16 v[12:15], v[100:103], v[16:19], v[12:15]
  s_waitcnt lgkmcnt(2)
  v_mfma_f32_16x16x32_bf16 v[8:11], v[108:111], v[60:63], v[8:11]
  ds_read2_b32 v[36:37], v127 offset0:144 offset1:145
  ds_read2_b32 v[38:39], v127 offset0:146 offset1:147
  v_mfma_f32_16x16x32_bf16 v[12:15], v[108:111], v[116:119], v[12:15]
  v_mfma_f32_16x16x32_bf16 v[12:15], v[164:167], v[20:23], v[12:15]
  s_waitcnt lgkmcnt(2)
  v_mfma_f32_16x16x32_bf16 v[8:11], v[24:27], v[40:43], v[8:11]
  v_mfma_f32_16x16x32_bf16 v[12:15], v[24:27], v[28:31], v[12:15]
  ds_read_b128 v[68:71], v120 offset:8192
  s_waitcnt lgkmcnt(1)
  v_mfma_f32_16x16x32_bf16 v[8:11], v[48:51], v[36:39], v[8:11]
  ds_read_b128 v[76:79], v120 offset:12288
  v_mfma_f32_16x16x32_bf16 v[12:15], v[48:51], v[60:63], v[12:15]
  ds_read2_b32 v[80:81], v126 offset0:128 offset1:129
  ds_read2_b32 v[82:83], v126 offset0:130 offset1:131
  ds_read_b128 v[84:87], v120 offset:28672
  v_mfma_f32_16x16x32_bf16 v[12:15], v[52:55], v[40:43], v[12:15]
  ds_read_b128 v[104:107], v120 offset:24576
  v_mfma_f32_16x16x32_bf16 v[12:15], v[92:95], v[36:39], v[12:15]
  ds_read2_b32 v[32:33], v126 offset0:112 offset1:113
  ds_read2_b32 v[34:35], v126 offset0:114 offset1:115
  ds_read_b128 v[96:99], v123 offset:26624
  v_and_b32 v152, v152, v4
  v_and_b32 v153, v153, v4
  v_and_b32 v154, v154, v4
  v_and_b32 v155, v155, v4
  s_waitcnt lgkmcnt(8)
  s_nop 0
  v_mfma_f32_16x16x32_bf16 v[8:11], v[152:155], v[68:71], v[8:11]
  ds_read_b128 v[44:47], v123 offset:22528
  s_waitcnt lgkmcnt(8)
  v_mfma_f32_16x16x32_bf16 v[12:15], v[152:155], v[76:79], v[12:15]
  ds_read2_b32 v[72:73], v126 offset0:96 offset1:97
  ds_read2_b32 v[74:75], v126 offset0:98 offset1:99
  ds_read_b128 v[56:59], v122 offset:26624
  s_waitcnt lgkmcnt(8)
  v_mfma_f32_16x16x32_bf16 v[12:15], v[80:83], v[84:87], v[12:15]
  ds_read_b128 v[64:67], v122 offset:22528
  s_waitcnt lgkmcnt(8)
  v_mfma_f32_16x16x32_bf16 v[8:11], v[80:83], v[104:107], v[8:11]
  ds_read2_b32 v[88:89], v126 offset0:80 offset1:81
  ds_read2_b32 v[90:91], v126 offset0:82 offset1:83
  ds_read_b128 v[112:115], v121 offset:26624
  s_waitcnt lgkmcnt(8)
  v_mfma_f32_16x16x32_bf16 v[12:15], v[32:35], v[96:99], v[12:15]
  ds_read_b128 v[100:103], v121 offset:22528
  s_waitcnt lgkmcnt(8)
  v_mfma_f32_16x16x32_bf16 v[8:11], v[32:35], v[44:47], v[8:11]
  ds_read2_b32 v[16:17], v126 offset0:64 offset1:65
  ds_read2_b32 v[18:19], v126 offset0:66 offset1:67
  ds_read_b128 v[108:111], v120 offset:26624
  s_waitcnt lgkmcnt(8)
  v_mfma_f32_16x16x32_bf16 v[12:15], v[72:75], v[56:59], v[12:15]
  ds_read_b128 v[116:119], v120 offset:22528
  s_waitcnt lgkmcnt(8)
  v_mfma_f32_16x16x32_bf16 v[8:11], v[72:75], v[64:67], v[8:11]
  ds_read2_b32 v[164:165], v126 offset0:48 offset1:49
  ds_read2_b32 v[166:167], v126 offset0:50 offset1:51
  ds_read_b128 v[20:23], v123 offset:24576
  s_waitcnt lgkmcnt(8)
  v_mfma_f32_16x16x32_bf16 v[12:15], v[88:91], v[112:115], v[12:15]
  ds_read_b128 v[24:27], v123 offset:20480
  s_waitcnt lgkmcnt(8)
  v_mfma_f32_16x16x32_bf16 v[8:11], v[88:91], v[100:103], v[8:11]
  ds_read2_b32 v[28:29], v126 offset0:32 offset1:33
  ds_read2_b32 v[30:31], v126 offset0:34 offset1:35
  ds_read_b128 v[48:51], v122 offset:24576
  s_waitcnt lgkmcnt(8)
  v_mfma_f32_16x16x32_bf16 v[12:15], v[16:19], v[108:111], v[12:15]
  ds_read_b128 v[60:63], v122 offset:20480
  s_waitcnt lgkmcnt(8)
  v_mfma_f32_16x16x32_bf16 v[8:11], v[16:19], v[116:119], v[8:11]
  ds_read2_b32 v[52:53], v126 offset0:16 offset1:17
  ds_read2_b32 v[54:55], v126 offset0:18 offset1:19
  ds_read_b128 v[40:43], v121 offset:24576
  s_waitcnt lgkmcnt(8)
  v_mfma_f32_16x16x32_bf16 v[12:15], v[164:167], v[20:23], v[12:15]
  ds_read_b128 v[92:95], v121 offset:20480
  s_waitcnt lgkmcnt(8)
  v_mfma_f32_16x16x32_bf16 v[8:11], v[164:167], v[24:27], v[8:11]
  ds_read2_b32 v[36:37], v126 offset0:0 offset1:1
  ds_read2_b32 v[38:39], v126 offset0:2 offset1:3
  s_waitcnt lgkmcnt(7)
  v_mfma_f32_16x16x32_bf16 v[12:15], v[28:31], v[48:51], v[12:15]
  ds_read_b128 v[68:71], v120 offset:20480
  s_waitcnt lgkmcnt(7)
  v_mfma_f32_16x16x32_bf16 v[8:11], v[28:31], v[60:63], v[8:11]
  ds_read2_b32 v[76:77], v125 offset0:112 offset1:113
  ds_read2_b32 v[78:79], v125 offset0:114 offset1:115
  s_waitcnt lgkmcnt(6)
  v_mfma_f32_16x16x32_bf16 v[12:15], v[52:55], v[40:43], v[12:15]
  ds_read_b128 v[84:87], v123 offset:18432
  s_waitcnt lgkmcnt(6)
  v_mfma_f32_16x16x32_bf16 v[8:11], v[52:55], v[92:95], v[8:11]
  ds_read2_b32 v[80:81], v125 offset0:96 offset1:97
  ds_read2_b32 v[82:83], v125 offset0:98 offset1:99
  s_waitcnt lgkmcnt(6)
  v_mfma_f32_16x16x32_bf16 v[12:15], v[36:39], v[104:107], v[12:15]
  ds_read_b128 v[96:99], v122 offset:18432
  s_waitcnt lgkmcnt(6)
  v_mfma_f32_16x16x32_bf16 v[8:11], v[36:39], v[68:71], v[8:11]
  ds_read2_b32 v[32:33], v125 offset0:80 offset1:81
  ds_read2_b32 v[34:35], v125 offset0:82 offset1:83
  s_waitcnt lgkmcnt(6)
  v_mfma_f32_16x16x32_bf16 v[12:15], v[76:79], v[44:47], v[12:15]
  ds_read_b128 v[56:59], v121 offset:18432
  s_waitcnt lgkmcnt(6)
  v_mfma_f32_16x16x32_bf16 v[8:11], v[76:79], v[84:87], v[8:11]
  ds_read2_b32 v[72:73], v125 offset0:64 offset1:65
  ds_read2_b32 v[74:75], v125 offset0:66 offset1:67
  s_waitcnt lgkmcnt(6)
  v_mfma_f32_16x16x32_bf16 v[12:15], v[80:83], v[64:67], v[12:15]
  ds_read_b128 v[112:115], v120 offset:18432
  s_waitcnt lgkmcnt(6)
  v_mfma_f32_16x16x32_bf16 v[8:11], v[80:83], v[96:99], v[8:11]
  ds_read2_b32 v[88:89], v125 offset0:48 offset1:49
  ds_read2_b32 v[90:91], v125 offset0:50 offset1:51
  s_waitcnt lgkmcnt(6)
  v_mfma_f32_16x16x32_bf16 v[12:15], v[32:35], v[100:103], v[12:15]
  ds_read_b128 v[108:111], v123 offset:16384
  s_waitcnt lgkmcnt(6)
  v_mfma_f32_16x16x32_bf16 v[8:11], v[32:35], v[56:59], v[8:11]
  ds_read2_b32 v[16:17], v125 offset0:32 offset1:33
  ds_read2_b32 v[18:19], v125 offset0:34 offset1:35
  s_waitcnt lgkmcnt(6)
  v_mfma_f32_16x16x32_bf16 v[12:15], v[72:75], v[116:119], v[12:15]
  ds_read_b128 v[20:23], v122 offset:16384
  s_waitcnt lgkmcnt(6)
  v_mfma_f32_16x16x32_bf16 v[8:11], v[72:75], v[112:115], v[8:11]
  ds_read2_b32 v[164:165], v125 offset0:16 offset1:17
  ds_read2_b32 v[166:167], v125 offset0:18 offset1:19
  s_waitcnt lgkmcnt(6)
  v_mfma_f32_16x16x32_bf16 v[12:15], v[88:91], v[24:27], v[12:15]
  ds_read_b128 v[48:51], v121 offset:16384
  s_waitcnt lgkmcnt(6)
  v_mfma_f32_16x16x32_bf16 v[8:11], v[88:91], v[108:111], v[8:11]
  ds_read2_b32 v[28:29], v125 offset0:0 offset1:1
  ds_read2_b32 v[30:31], v125 offset0:2 offset1:3
  s_waitcnt lgkmcnt(6)
  v_mfma_f32_16x16x32_bf16 v[12:15], v[16:19], v[60:63], v[12:15]
  ds_read_b128 v[40:43], v130 offset:0
  ds_read_b128 v[52:55], v120 offset:16384
  s_waitcnt lgkmcnt(7)
  v_mfma_f32_16x16x32_bf16 v[8:11], v[16:19], v[20:23], v[8:11]
  s_waitcnt lgkmcnt(5)
  v_mfma_f32_16x16x32_bf16 v[12:15], v[164:167], v[92:95], v[12:15]
  s_waitcnt lgkmcnt(4)
  v_mfma_f32_16x16x32_bf16 v[8:11], v[164:167], v[48:51], v[8:11]
  s_waitcnt lgkmcnt(2)
  v_mfma_f32_16x16x32_bf16 v[12:15], v[28:31], v[68:71], v[12:15]
  s_waitcnt lgkmcnt(0)
  v_mfma_f32_16x16x32_bf16 v[8:11], v[28:31], v[52:55], v[8:11]
  s_mov_b32 s38, 0x3f80
  s_mov_b32 s39, 0x3f800000
  v_lshlrev_b32 v132, 16, v40
  v_and_b32 v133, 0xffff0000, v40
  v_lshlrev_b32 v134, 16, v41
  v_and_b32 v135, 0xffff0000, v41
  v_lshlrev_b32 v136, 16, v42
  v_and_b32 v137, 0xffff0000, v42
  v_lshlrev_b32 v138, 16, v43
  v_and_b32 v139, 0xffff0000, v43
  v_cvt_pk_bf16_f32 v8, v8, v9
  v_cvt_pk_bf16_f32 v9, v10, v11
  ds_write_b64 v128, v[8:9] offset:0
  v_cvt_pk_bf16_f32 v12, v12, v13
  v_cvt_pk_bf16_f32 v13, v14, v15
  ds_write_b64 v128, v[12:13] offset:512
  s_mov_b64 exec, 1
  ds_add_u32 v162, v163 offset:8
  s_mov_b64 exec, -1
  s_mov_b32 s67, 0
F_fb2:
  ds_read_b32 v4, v162 offset:8
  s_add_u32 s67, s67, 1
  s_waitcnt lgkmcnt(0)
  v_readfirstlane_b32 s66, v4
  s_cmp_ge_u32 s66, 8
  s_cbranch_scc1 F_fb2_ok
  s_cmp_lt_u32 s67, 0xfffff
  s_cbranch_scc1 F_fb2
F_fb2_ok:
  ds_read_b64_tr_b16 v[80:81], v129 offset:0
  ds_read_b64_tr_b16 v[82:83], v129 offset:8448
  s_waitcnt lgkmcnt(1)
  v_dot2c_f32_bf16 v132, s38, v80
  v_dot2c_f32_bf16 v133, s39, v80
  v_dot2c_f32_bf16 v134, s38, v81
  v_dot2c_f32_bf16 v135, s39, v81
  s_waitcnt lgkmcnt(0)
  v_dot2c_f32_bf16 v136, s38, v82
  v_dot2c_f32_bf16 v137, s39, v82
  v_dot2c_f32_bf16 v138, s38, v83
  v_dot2c_f32_bf16 v139, s39, v83
  v_cvt_pk_bf16_f32 v80, v132, v133
  v_cvt_pk_bf16_f32 v81, v134, v135
  v_cvt_pk_bf16_f32 v82, v136, v137
  v_cvt_pk_bf16_f32 v83, v138, v139
  buffer_store_dwordx4 v[80:83], v131, s[4:7], s54 offen sc1
  s_endpgm
F_idle:
  s_cmp_eq_u32 s62, 8
  s_cbranch_scc1 F_end
  s_waitcnt lgkmcnt(0)
  v_mov_b32 v21, s62
  v_lshl_add_u32 v20, v21, 6, v2
  v_lshrrev_b32 v24, 3, v2
  v_and_b32 v25, 7, v2
  v_lshrrev_b32 v26, 4, v2
  v_and_b32 v27, 1, v21
  v_lshl_add_u32 v27, v27, 2, v26
  v_xor_b32 v27, v25, v27
  v_mul_u32_u24 v24, 10240, v24
  v_lshl_add_u32 v156, v27, 4, v24
  s_lshl_b32 s32, s60, 7
  s_add_u32 s64, s32, 23183360
  s_mul_i32 s56, s62, 81920
  s_add_u32 s32, s32, s56
  s_lshl_b32 s56, s62, 10
  v_lshlrev_b32 v157, 4, v2
  v_add_u32 v158, s56, v157
  v_add_u32 v160, 61440, v158
  v_lshlrev_b32 v161, 3, v20
  s_lshl_b32 s52, s60, 3
  s_add_u32 s52, s52, s62
  s_mul_i32 s52, s52, 3072
  s_add_u32 s52, s52, 2621440
  s_mul_i32 s53, s62, 3072
  s_add_u32 s53, s53, 36864
  v_add_u32 v159, s53, v157
  s_lshl_b32 s65, s61, 2
  s_add_u32 s65, s65, s64
  s_lshl_b32 s56, s26, 2
  s_add_u32 s64, s64, s56
  s_mov_b32 s40, s4
  s_mov_b32 s41, s5
  s_cmp_ge_u32 s61, 1
  s_cselect_b32 s42, s6, 0
  s_mov_b32 s43, s7
  s_mov_b32 s44, s4
  s_mov_b32 s45, s5
  s_cmp_eq_u32 s61, 2
  s_cselect_b32 s46, s6, 0
  s_mov_b32 s47, s7
  s_mov_b32 s48, s4
  s_mov_b32 s49, s5
  s_cmp_eq_u32 s61, 0
  s_cselect_b32 s50, s6, 0
  s_mov_b32 s51, s7
  s_lshl_b32 s57, s61, 9
  s_add_u32 s57, s57, 512
  s_cmp_eq_u32 s61, 0
  s_cselect_b32 s57, 0, s57
  s_mul_i32 s36, s57, 1280
  s_add_u32 s36, s36, s32
  s_add_u32 s36, s36, 20545536
  s_add_u32 s37, s36, 655360
  s_add_u32 s33, s32, 655360
  s_add_u32 s34, s32, 1310720
  s_add_u32 s35, s32, 1966080
  v_add_u32 v22, s57, v20
  v_lshlrev_b32 v131, 4, v22
  s_lshl_b32 s54, s60, 15
  s_add_u32 s54, s54, 4587520
  s_add_u32 s55, s54, 8192
  v_mov_b32 v162, 154368
  v_mov_b32 v163, 1
  v_and_b32 v23, 15, v2
  v_lshl_add_u32 v22, v23, 1, v26
  v_add_u32 v25, 30, v22
  v_bfe_u32 v24, v25, 1, 3
  v_xor_b32 v24, v24, v21
  v_lshlrev_b32 v25, 7, v25
  v_lshl_add_u32 v120, v24, 4, v25
  v_add_u32 v120, 98560, v120
  v_add_u32 v25, 34, v22
  v_bfe_u32 v24, v25, 1, 3
  v_xor_b32 v24, v24, v21
  v_lshlrev_b32 v25, 7, v25
  v_lshl_add_u32 v121, v24, 4, v25
  v_add_u32 v121, 98560, v121
  v_add_u32 v25, 38, v22
  v_bfe_u32 v24, v25, 1, 3
  v_xor_b32 v24, v24, v21
  v_lshlrev_b32 v25, 7, v25
  v_lshl_add_u32 v122, v24, 4, v25
  v_add_u32 v122, 98560, v122
  v_add_u32 v25, 42, v22
  v_bfe_u32 v24, v25, 1, 3
  v_xor_b32 v24, v24, v21
  v_lshlrev_b32 v25, 7, v25
  v_lshl_add_u32 v123, v24, 4, v25
  v_add_u32 v123, 98560, v123
  v_add_u32 v25, 29, v22
  v_bfe_u32 v24, v25, 1, 3
  v_xor_b32 v24, v24, v21
  v_lshlrev_b32 v25, 7, v25
  v_lshl_add_u32 v124, v24, 4, v25
  v_add_u32 v124, 98560, v124
  v_mov_b32 v28, 0
  v_mov_b32 v29, 0
  v_add_u32 v161, 98560, v161
  ds_write_b64 v161, v[28:29]
  v_sub_u32 v25, 15, v23
  v_lshrrev_b32 v25, 1, v25
  v_lshl_add_u32 v25, v26, 2, v25
  v_and_b32 v24, 1, v23
  v_xor_b32 v24, 1, v24
  v_mul_u32_u24 v24, 464, v24
  v_add_u32 v25, v25, v24
  v_lshl_add_u32 v125, v25, 2, s53
  v_add_u32 v126, 512, v125
  v_sub_u32 v25, 295, v23
  v_lshl_add_u32 v25, v26, 2, v25
  v_lshl_add_u32 v127, v25, 2, s53
  s_mul_i32 s56, s62, 2112
  s_add_u32 s56, s56, 77824
  v_lshlrev_b32 v25, 5, v23
  v_lshl_add_u32 v25, v26, 3, v25
  v_add_u32 v128, s56, v25
  v_bfe_u32 v25, v2, 2, 2
  v_mul_u32_u24 v25, 2112, v25
  v_and_b32 v24, 3, v2
  v_lshl_add_u32 v25, v24, 3, v25
  v_lshrrev_b32 v24, 4, v20
  v_lshl_add_u32 v25, v24, 5, v25
  v_add_u32 v129, 77824, v25
  v_lshlrev_b32 v25, 3, v26
  v_sub_u32 v25, v23, v25
  v_add_u32 v24, 15, v25
  v_add_u32 v25, 16, v25
  v_and_b32 v25, 0xffff, v25
  v_lshl_or_b32 v25, v24, 16, v25
  s_mov_b32 s39, 0x3f803f80
  v_pk_sub_i16 v40, v25, 3 op_sel_hi:[1,0]
  v_pk_sub_i16 v41, v25, 4 op_sel_hi:[1,0]
  v_pk_sub_i16 v42, v25, 5 op_sel_hi:[1,0]
  v_pk_sub_i16 v43, v25, 6 op_sel_hi:[1,0]
  v_pk_sub_i16 v44, v25, 7 op_sel_hi:[1,0]
  v_pk_sub_i16 v45, v25, 8 op_sel_hi:[1,0]
  v_pk_sub_i16 v46, v25, 9 op_sel_hi:[1,0]
  v_pk_sub_i16 v47, v25, 10 op_sel_hi:[1,0]
  v_pk_sub_i16 v48, v25, 11 op_sel_hi:[1,0]
  v_pk_sub_i16 v49, v25, 12 op_sel_hi:[1,0]
  v_pk_sub_i16 v50, v25, 13 op_sel_hi:[1,0]
  v_pk_sub_i16 v51, v25, 14 op_sel_hi:[1,0]
  v_pk_sub_i16 v52, v25, 15 op_sel_hi:[1,0]
  v_pk_sub_i16 v53, v25, 16 op_sel_hi:[1,0]
  v_pk_sub_i16 v54, v25, 17 op_sel_hi:[1,0]
  v_pk_sub_i16 v55, v25, 18 op_sel_hi:[1,0]
  v_pk_sub_i16 v56, v25, 19 op_sel_hi:[1,0]
  v_pk_sub_i16 v57, v25, 20 op_sel_hi:[1,0]
  v_pk_ashrrev_i16 v40, 15, v40 op_sel_hi:[0,1]
  v_pk_ashrrev_i16 v41, 15, v41 op_sel_hi:[0,1]
  v_pk_ashrrev_i16 v42, 15, v42 op_sel_hi:[0,1]
  v_pk_ashrrev_i16 v43, 15, v43 op_sel_hi:[0,1]
  v_pk_ashrrev_i16 v44, 15, v44 op_sel_hi:[0,1]
  v_pk_ashrrev_i16 v45, 15, v45 op_sel_hi:[0,1]
  v_pk_ashrrev_i16 v46, 15, v46 op_sel_hi:[0,1]
  v_pk_ashrrev_i16 v47, 15, v47 op_sel_hi:[0,1]
  v_pk_ashrrev_i16 v48, 15, v48 op_sel_hi:[0,1]
  v_pk_ashrrev_i16 v49, 15, v49 op_sel_hi:[0,1]
  v_pk_ashrrev_i16 v50, 15, v50 op_sel_hi:[0,1]
  v_pk_ashrrev_i16 v51, 15, v51 op_sel_hi:[0,1]
  v_pk_ashrrev_i16 v52, 15, v52 op_sel_hi:[0,1]
  v_pk_ashrrev_i16 v53, 15, v53 op_sel_hi:[0,1]
  v_pk_ashrrev_i16 v54, 15, v54 op_sel_hi:[0,1]
  v_pk_ashrrev_i16 v55, 15, v55 op_sel_hi:[0,1]
  v_pk_ashrrev_i16 v56, 15, v56 op_sel_hi:[0,1]
  v_pk_ashrrev_i16 v57, 15, v57 op_sel_hi:[0,1]
  v_bitop3_b32 v132, v40, v43, s39 bitop3:0x28
  v_bitop3_b32 v133, v42, v45, s39 bitop3:0x28
  v_bitop3_b32 v134, v44, v47, s39 bitop3:0x28
  v_bitop3_b32 v135, v46, v49, s39 bitop3:0x28
  v_bitop3_b32 v136, v43, v48, s39 bitop3:0x28
  v_bitop3_b32 v137, v45, v50, s39 bitop3:0x28
  v_bitop3_b32 v138, v47, v52, s39 bitop3:0x28
  v_bitop3_b32 v139, v49, v54, s39 bitop3:0x28
  v_bitop3_b32 v140, v48, v51, s39 bitop3:0x28
  v_bitop3_b32 v141, v50, v53, s39 bitop3:0x28
  v_bitop3_b32 v142, v52, v55, s39 bitop3:0x28
  v_bitop3_b32 v143, v54, v57, s39 bitop3:0x28
  v_bitop3_b32 v144, v42, v49, s39 bitop3:0x28
  v_bitop3_b32 v145, v44, v51, s39 bitop3:0x28
  v_bitop3_b32 v146, v46, v53, s39 bitop3:0x28
  v_bitop3_b32 v147, v48, v55, s39 bitop3:0x28
  v_bitop3_b32 v148, v41, v50, s39 bitop3:0x28
  v_bitop3_b32 v149, v43, v52, s39 bitop3:0x28
  v_bitop3_b32 v150, v45, v54, s39 bitop3:0x28
  v_bitop3_b32 v151, v47, v56, s39 bitop3:0x28
  v_xor_b32 v152, v40, v42
  v_xor_b32 v153, v42, v44
  v_xor_b32 v154, v44, v46
  v_xor_b32 v155, v46, v48
  v_lshlrev_b32 v130, 4, v20
  v_add_u32 v130, 137984, v130
  s_waitcnt lgkmcnt(0)
  s_barrier
  s_barrier
  s_barrier
  s_branch F_b
F_m8:
  s_barrier
  s_barrier
  s_endpgm
F_init:
  s_cmp_lg_u32 s2, 255
  s_cbranch_scc1 F_end
  s_cmp_lg_u32 s62, 0
  s_cbranch_scc1 F_end
  s_load_dwordx2 s[8:9], s[0:1], 96
  s_mov_b32 s10, 256
  s_mov_b32 s11, 0x00020000
  v_mov_b32 v8, 0
  v_mov_b32 v9, 0
  v_mov_b32 v10, 0
  v_mov_b32 v11, 0
  v_lshlrev_b32 v4, 4, v2
  v_lshlrev_b32 v5, 7, v2
  s_mov_b32 s12, 23166976
  s_mov_b32 s15, 23175168
  s_mov_b32 s13, 23183360
  s_mov_b32 s14, 23185408
  v_mov_b32 v6, 1
  s_waitcnt lgkmcnt(0)
  buffer_store_dwordx4 v[8:11], v5, s[4:7], s15 offen sc1
  s_waitcnt vmcnt(0)
  s_mov_b64 exec, 1
  buffer_store_dword v6, off, s[8:11], 0 sc1
  s_mov_b64 exec, -1
  s_endpgm
F_ez:
  v_mov_b32 v8, 0
  v_mov_b32 v9, 0
  v_mov_b32 v10, 0
  v_mov_b32 v11, 0
  v_lshlrev_b32 v5, 7, v2
  s_mov_b32 s12, 23166976
  s_cmp_eq_u32 s62, 11
  s_cbranch_scc1 F_end
  buffer_store_dwordx4 v[8:11], v5, s[4:7], s12 offen sc1
  s_endpgm
F_side:
  s_setprio 3
  s_load_dwordx2 s[8:9], s[0:1], 0
  s_mov_b32 s10, 2621440
  s_mov_b32 s11, 0x00020000
  s_load_dwordx2 s[16:17], s[0:1], 96
  s_mov_b32 s18, 256
  s_mov_b32 s19, 0x00020000
  v_lshlrev_b32 v9, 4, v2
  s_mov_b32 s30, 0x3f803f80
  v_lshrrev_b32 v3, 3, v2
  v_and_b32 v4, 7, v2
  v_lshlrev_b32 v4, 4, v4
  v_mul_u32_u24 v5, 1280, v3
  v_add_u32 v5, v5, v4
  s_mul_i32 s12, s2, 10240
  s_sub_u32 s28, s62, 9
  s_lshl_b32 s29, s28, 2
  s_lshr_b32 s13, s28, 1
  s_sub_u32 s29, s29, s13
  s_lshl_b32 s29, s29, 7
  s_add_u32 s13, s12, s29
  s_waitcnt lgkmcnt(0)
  s_mov_b32 s36, s8
  s_mov_b32 s37, s9
  s_cmp_eq_u32 s28, 0
  s_cselect_b32 s38, s10, 0
  s_mov_b32 s39, s11
  buffer_load_dwordx4 v[16:19], v5, s[8:11], s13 offen offset:0
  buffer_load_dwordx4 v[20:23], v5, s[8:11], s13 offen offset:128
  buffer_load_dwordx4 v[24:27], v5, s[8:11], s13 offen offset:256
  buffer_load_dwordx4 v[28:31], v5, s[36:39], s13 offen offset:384
  v_mov_b32 v112, -1
  v_mov_b32 v113, -1
  v_mov_b32 v114, -1
  v_mov_b32 v115, -1
  s_mul_i32 s26, s61, 3
  s_add_u32 s26, s26, s28
  s_lshl_b32 s25, s60, 3
  s_add_u32 s25, s25, s26
  s_mul_i32 s25, s25, 3072
  s_add_u32 s25, s25, 2621440
  s_mov_b32 s32, s4
  s_mov_b32 s33, s5
  s_cmp_lt_u32 s26, 8
  s_cselect_b32 s34, s6, 0
  s_mov_b32 s35, s7
  s_getpc_b64 s[20:21]
A_pc0:
  s_add_u32 s20, s20, kA_kernel-A_pc0
  s_addc_u32 s21, s21, -1
  s_lshr_b32 s22, s2, 3
  s_lshl_b32 s22, s22, 1
  s_and_b32 s23, s62, 1
  s_add_u32 s22, s22, s23
  s_lshl_b32 s22, s22, 12
  v_lshlrev_b32 v118, 6, v2
  v_add_u32 v118, s22, v118
  v_min_u32 v118, code_end-kA_kernel, v118
  global_load_dword v117, v118, s[20:21]
  v_lshlrev_b32 v119, 3, v2
  v_add_u32 v119, 154432, v119
  s_lshl_b32 s26, s28, 9
  v_add_u32 v111, s26, v119
  ds_write_b64 v111, v[112:113]
  v_mov_b32 v10, 0
  v_mov_b32 v11, 0
  v_mov_b32 v12, 0
  v_mov_b32 v13, 0
  s_lshl_b32 s26, s28, 2
  s_add_u32 s26, s26, 154364
  s_cmp_lg_u32 s28, 0
  s_cselect_b32 s26, s26, 154368
  v_mov_b32 v116, s26
  s_cbranch_scc1 F_l3a
  ds_write_b128 v116, v[10:13]
F_l3a:
  s_add_u32 s29, s29, 87808
  v_mul_u32_u24 v6, 1344, v3
  v_add3_u32 v6, v6, v4, s29
  v_bfe_u32 v7, v2, 2, 2
  v_mul_u32_u24 v7, 1344, v7
  v_and_b32 v8, 3, v2
  v_lshl_add_u32 v7, v8, 3, v7
  v_bfe_u32 v8, v2, 4, 2
  v_lshl_add_u32 v7, v8, 5, v7
  v_add_u32 v7, s29, v7
  s_sub_u32 s29, s29, 87808
  s_lshl_b32 s29, s29, 3
  s_add_u32 s12, s12, s29
  s_and_b32 s23, s2, 63
  s_lshl_b32 s23, s23, 7
  s_lshr_b32 s24, s2, 6
  s_lshl_b32 s24, s24, 2
  s_add_u32 s23, s23, s24
  s_add_u32 s23, s23, 23175168
  s_mov_b32 s24, 23175168
  v_lshlrev_b32 v8, 7, v2
  s_waitcnt lgkmcnt(0)
  s_barrier
  s_waitcnt vmcnt(4)
  v_dot2c_f32_bf16 v10, s30, v16
  v_dot2c_f32_bf16 v11, v16, v16
  v_lshlrev_b32 v120, 16, v16
  v_and_b32 v121, 0xffff0000, v16
  v_dot2c_f32_bf16 v12, s30, v17
  v_dot2c_f32_bf16 v13, v17, v17
  v_lshlrev_b32 v122, 16, v17
  v_and_b32 v123, 0xffff0000, v17
  v_dot2c_f32_bf16 v10, s30, v18
  v_dot2c_f32_bf16 v11, v18, v18
  v_lshlrev_b32 v124, 16, v18
  v_and_b32 v125, 0xffff0000, v18
  v_dot2c_f32_bf16 v12, s30, v19
  v_dot2c_f32_bf16 v13, v19, v19
  v_lshlrev_b32 v126, 16, v19
  v_and_b32 v127, 0xffff0000, v19
  s_waitcnt vmcnt(3)
  v_dot2c_f32_bf16 v10, s30, v20
  v_dot2c_f32_bf16 v11, v20, v20
  v_lshlrev_b32 v128, 16, v20
  v_and_b32 v129, 0xffff0000, v20
  v_dot2c_f32_bf16 v12, s30, v21
  v_dot2c_f32_bf16 v13, v21, v21
  v_lshlrev_b32 v130, 16, v21
  v_and_b32 v131, 0xffff0000, v21
  v_dot2c_f32_bf16 v10, s30, v22
  v_dot2c_f32_bf16 v11, v22, v22
  v_lshlrev_b32 v132, 16, v22
  v_and_b32 v133, 0xffff0000, v22
  v_dot2c_f32_bf16 v12, s30, v23
  v_dot2c_f32_bf16 v13, v23, v23
  v_lshlrev_b32 v134, 16, v23
  v_and_b32 v135, 0xffff0000, v23
  s_waitcnt vmcnt(2)
  v_dot2c_f32_bf16 v10, s30, v24
  v_dot2c_f32_bf16 v11, v24, v24
  v_lshlrev_b32 v136, 16, v24
  v_and_b32 v137, 0xffff0000, v24
  v_dot2c_f32_bf16 v12, s30, v25
  v_dot2c_f32_bf16 v13, v25, v25
  v_lshlrev_b32 v138, 16, v25
  v_and_b32 v139, 0xffff0000, v25
  v_dot2c_f32_bf16 v10, s30, v26
  v_dot2c_f32_bf16 v11, v26, v26
  v_lshlrev_b32 v140, 16, v26
  v_and_b32 v141, 0xffff0000, v26
  v_dot2c_f32_bf16 v12, s30, v27
  v_dot2c_f32_bf16 v13, v27, v27
  v_lshlrev_b32 v142, 16, v27
  v_and_b32 v143, 0xffff0000, v27
  s_waitcnt vmcnt(1)
  v_dot2c_f32_bf16 v10, s30, v28
  v_dot2c_f32_bf16 v11, v28, v28
  v_lshlrev_b32 v144, 16, v28
  v_and_b32 v145, 0xffff0000, v28
  v_dot2c_f32_bf16 v12, s30, v29
  v_dot2c_f32_bf16 v13, v29, v29
  v_lshlrev_b32 v146, 16, v29
  v_and_b32 v147, 0xffff0000, v29
  v_dot2c_f32_bf16 v10, s30, v30
  v_dot2c_f32_bf16 v11, v30, v30
  v_lshlrev_b32 v148, 16, v30
  v_and_b32 v149, 0xffff0000, v30
  v_dot2c_f32_bf16 v12, s30, v31
  v_dot2c_f32_bf16 v13, v31, v31
  v_lshlrev_b32 v150, 16, v31
  v_and_b32 v151, 0xffff0000, v31
  v_add_f32 v10, v10, v12
  v_add_f32 v11, v11, v13
  s_nop 0
  v_add_f32_dpp v10, v10, v10 quad_perm:[1,0,3,2] row_mask:0xf bank_mask:0xf
  v_add_f32_dpp v11, v11, v11 quad_perm:[1,0,3,2] row_mask:0xf bank_mask:0xf
  s_nop 0
  v_add_f32_dpp v10, v10, v10 quad_perm:[2,3,0,1] row_mask:0xf bank_mask:0xf
  v_add_f32_dpp v11, v11, v11 quad_perm:[2,3,0,1] row_mask:0xf bank_mask:0xf
  s_nop 0
  v_add_f32_dpp v10, v10, v10 row_half_mirror row_mask:0xf bank_mask:0xf
  v_add_f32_dpp v11, v11, v11 row_half_mirror row_mask:0xf bank_mask:0xf
  ds_write_b64 v111, v[10:11]
  s_mov_b32 s67, 0
F_ps:
  ds_read_b64 v[10:11], v119
  ds_read_b64 v[12:13], v119 offset:512
  ds_read_b64 v[14:15], v119 offset:1024
  s_add_u32 s67, s67, 1
  s_waitcnt lgkmcnt(0)
  v_max3_u32 v110, v11, v13, v15
  v_cmp_eq_u32 vcc, -1, v110
  v_add_f32 v10, v10, v12
  v_add_f32 v11, v11, v13
  s_cmp_eq_u64 vcc, 0
  s_cbranch_scc1 F_ps_ok
  s_cmp_lt_u32 s67, 0xffff
  s_cbranch_scc1 F_ps
F_ps_ok:
  v_add_f32 v10, v10, v14
  v_add_f32 v11, v11, v15
  v_mul_f32 v10, 0xbacccccd, v10
  v_mul_f32 v11, 0x3acccccd, v11
  v_fma_f32 v11, -v10, v10, v11
  v_max_f32 v11, 0, v11
  v_cvt_pk_bf16_f32 v11, v10, v11
  v_lshlrev_b32 v10, 16, v11
  v_and_b32 v11, 0xffff0000, v11
  v_add_f32 v11, 0x3727c5ac, v11
  v_cvt_pk_bf16_f32 v11, v11, v11
  v_and_b32 v11, 0xffff0000, v11
  v_sqrt_f32 v11, v11
  s_nop 0
  v_cvt_pk_bf16_f32 v11, v11, v11
  v_and_b32 v11, 0xffff0000, v11
  v_rcp_f32 v12, v11
  s_nop 0
  v_mul_f32 v14, v10, v12
  v_pk_fma_f32 v[120:121], v[120:121], v[12:13], v[14:15] op_sel_hi:[1,0,0]
  v_pk_fma_f32 v[122:123], v[122:123], v[12:13], v[14:15] op_sel_hi:[1,0,0]
  v_pk_fma_f32 v[124:125], v[124:125], v[12:13], v[14:15] op_sel_hi:[1,0,0]
  v_pk_fma_f32 v[126:127], v[126:127], v[12:13], v[14:15] op_sel_hi:[1,0,0]
  v_cvt_pk_bf16_f32 v16, v120, v121
  v_cvt_pk_bf16_f32 v17, v122, v123
  v_cvt_pk_bf16_f32 v18, v124, v125
  v_cvt_pk_bf16_f32 v19, v126, v127
  ds_write_b128 v6, v[16:19] offset:0
  ds_read_b64_tr_b16 v[64:65], v7 offset:0
  ds_read_b64_tr_b16 v[66:67], v7 offset:5376
  v_pk_fma_f32 v[128:129], v[128:129], v[12:13], v[14:15] op_sel_hi:[1,0,0]
  v_pk_fma_f32 v[130:131], v[130:131], v[12:13], v[14:15] op_sel_hi:[1,0,0]
  v_pk_fma_f32 v[132:133], v[132:133], v[12:13], v[14:15] op_sel_hi:[1,0,0]
  v_pk_fma_f32 v[134:135], v[134:135], v[12:13], v[14:15] op_sel_hi:[1,0,0]
  v_cvt_pk_bf16_f32 v20, v128, v129
  v_cvt_pk_bf16_f32 v21, v130, v131
  v_cvt_pk_bf16_f32 v22, v132, v133
  v_cvt_pk_bf16_f32 v23, v134, v135
  ds_write_b128 v6, v[20:23] offset:128
  ds_read_b64_tr_b16 v[68:69], v7 offset:128
  ds_read_b64_tr_b16 v[70:71], v7 offset:5504
  s_waitcnt lgkmcnt(3)
  buffer_store_dwordx4 v[64:67], v9, s[4:7], s12 offen offset:0 sc1
  v_pk_fma_f32 v[136:137], v[136:137], v[12:13], v[14:15] op_sel_hi:[1,0,0]
  v_pk_fma_f32 v[138:139], v[138:139], v[12:13], v[14:15] op_sel_hi:[1,0,0]
  v_pk_fma_f32 v[140:141], v[140:141], v[12:13], v[14:15] op_sel_hi:[1,0,0]
  v_pk_fma_f32 v[142:143], v[142:143], v[12:13], v[14:15] op_sel_hi:[1,0,0]
  v_cvt_pk_bf16_f32 v24, v136, v137
  v_cvt_pk_bf16_f32 v25, v138, v139
  v_cvt_pk_bf16_f32 v26, v140, v141
  v_cvt_pk_bf16_f32 v27, v142, v143
  ds_write_b128 v6, v[24:27] offset:256
  ds_read_b64_tr_b16 v[72:73], v7 offset:256
  ds_read_b64_tr_b16 v[74:75], v7 offset:5632
  s_waitcnt lgkmcnt(3)
  buffer_store_dwordx4 v[68:71], v9, s[4:7], s12 offen offset:1024 sc1
  s_cmp_eq_u32 s28, 0
  s_cbranch_scc1 F_l3b
  s_waitcnt lgkmcnt(0)
  buffer_store_dwordx4 v[72:75], v9, s[4:7], s12 offen offset:2048 sc1
  buffer_store_dwordx4 v[112:115], v9, s[32:35], s25 offen offset:0 sc1
  buffer_store_dwordx4 v[112:115], v9, s[32:35], s25 offen offset:1024 sc1
  buffer_store_dwordx4 v[112:115], v9, s[32:35], s25 offen offset:2048 sc1
  v_mov_b32 v3, 1
  s_waitcnt vmcnt(0)
  ds_write_b32 v116, v3
  s_setprio 0
  s_waitcnt lgkmcnt(0)
  s_branch F_shuf
F_l3b:
  v_pk_fma_f32 v[144:145], v[144:145], v[12:13], v[14:15] op_sel_hi:[1,0,0]
  v_pk_fma_f32 v[146:147], v[146:147], v[12:13], v[14:15] op_sel_hi:[1,0,0]
  v_pk_fma_f32 v[148:149], v[148:149], v[12:13], v[14:15] op_sel_hi:[1,0,0]
  v_pk_fma_f32 v[150:151], v[150:151], v[12:13], v[14:15] op_sel_hi:[1,0,0]
  v_cvt_pk_bf16_f32 v28, v144, v145
  v_cvt_pk_bf16_f32 v29, v146, v147
  v_cvt_pk_bf16_f32 v30, v148, v149
  v_cvt_pk_bf16_f32 v31, v150, v151
  ds_write_b128 v6, v[28:31] offset:384
  ds_read_b64_tr_b16 v[76:77], v7 offset:384
  ds_read_b64_tr_b16 v[78:79], v7 offset:5760
  s_waitcnt lgkmcnt(3)
  buffer_store_dwordx4 v[72:75], v9, s[4:7], s12 offen offset:2048 sc1
  s_waitcnt lgkmcnt(0)
  buffer_store_dwordx4 v[76:79], v9, s[4:7], s12 offen offset:3072 sc1
  buffer_store_dwordx4 v[112:115], v9, s[32:35], s25 offen offset:0 sc1
  buffer_store_dwordx4 v[112:115], v9, s[32:35], s25 offen offset:1024 sc1
  buffer_store_dwordx4 v[112:115], v9, s[32:35], s25 offen offset:2048 sc1
  v_mov_b32 v3, 1
  s_lshl_b32 s12, s61, 9
  s_add_u32 s12, s12, 512
  s_cmp_eq_u32 s61, 0
  s_cselect_b32 s12, 0, s12
  s_mul_i32 s12, s12, 1280
  s_lshl_b32 s14, s60, 4
  s_add_u32 s12, s12, s14
  v_mul_u32_u24 v21, 1280, v2
  s_mov_b32 s67, 0
F_go:
  buffer_load_dword v10, off, s[16:19], 0 sc1
  s_add_u32 s67, s67, 1
  s_waitcnt vmcnt(0)
  s_cmp_gt_u32 s67, 0xffff
  s_cbranch_scc1 F_go_ok
  v_readfirstlane_b32 s66, v10
  s_cmp_lg_u32 s66, 1
  s_cbranch_scc1 F_go
F_go_ok:
  s_mov_b32 s67, 0
F_mb:
  ds_read_b64 v[10:11], v116
  s_add_u32 s67, s67, 1
  s_waitcnt lgkmcnt(0)
  v_and_b32 v10, v10, v11
  s_nop 0
  v_readfirstlane_b32 s66, v10
  s_cmp_eq_u32 s66, 1
  s_cbranch_scc1 F_mb_ok
  s_cmp_lt_u32 s67, 0xffff
  s_cbranch_scc1 F_mb
F_mb_ok:
  s_mov_b64 exec, 1
  buffer_store_dword v3, off, s[4:7], s23 sc1
  s_mov_b64 exec, -1
  s_cmp_ge_u32 s2, 240
  s_cbranch_scc1 F_send
  s_mov_b32 m0, 137984
  s_add_u32 s14, s12, 0
  buffer_load_dwordx4 v21, s[8:11], s14 offen lds
  s_mov_b32 m0, 139008
  s_add_u32 s14, s12, 81920
  buffer_load_dwordx4 v21, s[8:11], s14 offen lds
  s_mov_b32 m0, 140032
  s_add_u32 s14, s12, 163840
  buffer_load_dwordx4 v21, s[8:11], s14 offen lds
  s_mov_b32 m0, 141056
  s_add_u32 s14, s12, 245760
  buffer_load_dwordx4 v21, s[8:11], s14 offen lds
  s_mov_b32 m0, 142080
  s_add_u32 s14, s12, 327680
  buffer_load_dwordx4 v21, s[8:11], s14 offen lds
  s_mov_b32 m0, 143104
  s_add_u32 s14, s12, 409600
  buffer_load_dwordx4 v21, s[8:11], s14 offen lds
  s_mov_b32 m0, 144128
  s_add_u32 s14, s12, 491520
  buffer_load_dwordx4 v21, s[8:11], s14 offen lds
  s_mov_b32 m0, 145152
  s_add_u32 s14, s12, 573440
  buffer_load_dwordx4 v21, s[8:11], s14 offen lds
  s_cmp_lg_u32 s61, 0
  s_cbranch_scc1 F_l3c
  s_mov_b32 m0, 146176
  s_add_u32 s14, s12, 655360
  buffer_load_dwordx4 v21, s[8:11], s14 offen lds
  s_mov_b32 m0, 147200
  s_add_u32 s14, s12, 737280
  buffer_load_dwordx4 v21, s[8:11], s14 offen lds
  s_mov_b32 m0, 148224
  s_add_u32 s14, s12, 819200
  buffer_load_dwordx4 v21, s[8:11], s14 offen lds
  s_mov_b32 m0, 149248
  s_add_u32 s14, s12, 901120
  buffer_load_dwordx4 v21, s[8:11], s14 offen lds
  s_mov_b32 m0, 150272
  s_add_u32 s14, s12, 983040
  buffer_load_dwordx4 v21, s[8:11], s14 offen lds
  s_mov_b32 m0, 151296
  s_add_u32 s14, s12, 1064960
  buffer_load_dwordx4 v21, s[8:11], s14 offen lds
  s_mov_b32 m0, 152320
  s_add_u32 s14, s12, 1146880
  buffer_load_dwordx4 v21, s[8:11], s14 offen lds
  s_mov_b32 m0, 153344
  s_add_u32 s14, s12, 1228800
  buffer_load_dwordx4 v21, s[8:11], s14 offen lds
F_l3c:
  v_lshrrev_b32 v22, 3, v2
  v_mul_u32_u24 v22, 10240, v22
  v_and_b32 v23, 7, v2
  v_lshrrev_b32 v24, 4, v2
  v_xor_b32 v23, v23, v24
  v_lshl_add_u32 v22, v23, 4, v22
  v_xor_b32 v23, 64, v22
  s_lshl_b32 s12, s60, 7
  s_barrier
  buffer_load_dwordx4 v[12:15], v8, s[4:7], s24 offen sc1
  s_barrier
  s_waitcnt vmcnt(0)
  v_and_b32 v12, v12, v13
  v_and_b32 v14, v14, v15
  v_and_b32 v12, v12, v14
  v_cmp_ne_u32 vcc, 1, v12
  s_nop 1
  s_cmp_eq_u64 vcc, 0
  s_cbranch_scc1 F_ln_ok
  s_mov_b32 s67, 0
F_ln:
  buffer_load_dwordx4 v[12:15], v8, s[4:7], s24 offen sc1
  s_add_u32 s67, s67, 1
  s_waitcnt vmcnt(0)
  s_cmp_gt_u32 s67, 0xffff
  s_cbranch_scc1 F_ln_ok
  v_and_b32 v12, v12, v13
  v_and_b32 v14, v14, v15
  v_and_b32 v12, v12, v14
  v_cmp_ne_u32 vcc, 1, v12
  s_nop 1
  s_cmp_lg_u64 vcc, 0
  s_cbranch_scc1 F_ln
F_ln_ok:
  s_mov_b32 m0, 102656
  s_add_u32 s14, s12, 0
  buffer_load_dwordx4 v22, s[4:7], s14 offen sc1 lds
  s_mov_b32 m0, 103680
  s_add_u32 s14, s12, 81920
  buffer_load_dwordx4 v23, s[4:7], s14 offen sc1 lds
  s_mov_b32 m0, 104704
  s_add_u32 s14, s12, 163840
  buffer_load_dwordx4 v22, s[4:7], s14 offen sc1 lds
  s_mov_b32 m0, 105728
  s_add_u32 s14, s12, 245760
  buffer_load_dwordx4 v23, s[4:7], s14 offen sc1 lds
  s_mov_b32 m0, 106752
  s_add_u32 s14, s12, 327680
  buffer_load_dwordx4 v22, s[4:7], s14 offen sc1 lds
  s_mov_b32 m0, 107776
  s_add_u32 s14, s12, 409600
  buffer_load_dwordx4 v23, s[4:7], s14 offen sc1 lds
  s_mov_b32 m0, 108800
  s_add_u32 s14, s12, 491520
  buffer_load_dwordx4 v22, s[4:7], s14 offen sc1 lds
  s_mov_b32 m0, 109824
  s_add_u32 s14, s12, 573440
  buffer_load_dwordx4 v23, s[4:7], s14 offen sc1 lds
  s_mov_b32 m0, 110848
  s_add_u32 s14, s12, 655360
  buffer_load_dwordx4 v22, s[4:7], s14 offen sc1 lds
  s_mov_b32 m0, 111872
  s_add_u32 s14, s12, 737280
  buffer_load_dwordx4 v23, s[4:7], s14 offen sc1 lds
  s_mov_b32 m0, 112896
  s_add_u32 s14, s12, 819200
  buffer_load_dwordx4 v22, s[4:7], s14 offen sc1 lds
  s_mov_b32 m0, 113920
  s_add_u32 s14, s12, 901120
  buffer_load_dwordx4 v23, s[4:7], s14 offen sc1 lds
  s_mov_b32 m0, 114944
  s_add_u32 s14, s12, 983040
  buffer_load_dwordx4 v22, s[4:7], s14 offen sc1 lds
  s_mov_b32 m0, 115968
  s_add_u32 s14, s12, 1064960
  buffer_load_dwordx4 v23, s[4:7], s14 offen sc1 lds
  s_mov_b32 m0, 116992
  s_add_u32 s14, s12, 1146880
  buffer_load_dwordx4 v22, s[4:7], s14 offen sc1 lds
  s_mov_b32 m0, 118016
  s_add_u32 s14, s12, 1228800
  buffer_load_dwordx4 v23, s[4:7], s14 offen sc1 lds
  s_cmp_lt_u32 s61, 1
  s_cbranch_scc1 F_ude
  s_mov_b32 m0, 119040
  s_add_u32 s14, s12, 1310720
  buffer_load_dwordx4 v22, s[4:7], s14 offen sc1 lds
  s_mov_b32 m0, 120064
  s_add_u32 s14, s12, 1392640
  buffer_load_dwordx4 v23, s[4:7], s14 offen sc1 lds
  s_mov_b32 m0, 121088
  s_add_u32 s14, s12, 1474560
  buffer_load_dwordx4 v22, s[4:7], s14 offen sc1 lds
  s_mov_b32 m0, 122112
  s_add_u32 s14, s12, 1556480
  buffer_load_dwordx4 v23, s[4:7], s14 offen sc1 lds
  s_mov_b32 m0, 123136
  s_add_u32 s14, s12, 1638400
  buffer_load_dwordx4 v22, s[4:7], s14 offen sc1 lds
  s_mov_b32 m0, 124160
  s_add_u32 s14, s12, 1720320
  buffer_load_dwordx4 v23, s[4:7], s14 offen sc1 lds
  s_mov_b32 m0, 125184
  s_add_u32 s14, s12, 1802240
  buffer_load_dwordx4 v22, s[4:7], s14 offen sc1 lds
  s_mov_b32 m0, 126208
  s_add_u32 s14, s12, 1884160
  buffer_load_dwordx4 v23, s[4:7], s14 offen sc1 lds
  s_cmp_lt_u32 s61, 2
  s_cbranch_scc1 F_ude
  s_mov_b32 m0, 127232
  s_add_u32 s14, s12, 1966080
  buffer_load_dwordx4 v22, s[4:7], s14 offen sc1 lds
  s_mov_b32 m0, 128256
  s_add_u32 s14, s12, 2048000
  buffer_load_dwordx4 v23, s[4:7], s14 offen sc1 lds
  s_mov_b32 m0, 129280
  s_add_u32 s14, s12, 2129920
  buffer_load_dwordx4 v22, s[4:7], s14 offen sc1 lds
  s_mov_b32 m0, 130304
  s_add_u32 s14, s12, 2211840
  buffer_load_dwordx4 v23, s[4:7], s14 offen sc1 lds
  s_mov_b32 m0, 131328
  s_add_u32 s14, s12, 2293760
  buffer_load_dwordx4 v22, s[4:7], s14 offen sc1 lds
  s_mov_b32 m0, 132352
  s_add_u32 s14, s12, 2375680
  buffer_load_dwordx4 v23, s[4:7], s14 offen sc1 lds
  s_mov_b32 m0, 133376
  s_add_u32 s14, s12, 2457600
  buffer_load_dwordx4 v22, s[4:7], s14 offen sc1 lds
  s_mov_b32 m0, 134400
  s_add_u32 s14, s12, 2539520
  buffer_load_dwordx4 v23, s[4:7], s14 offen sc1 lds
F_ude:
  s_waitcnt vmcnt(0)
  s_barrier
F_send:
  s_endpgm
F_shuf:
  s_load_dwordx4 s[40:43], s[0:1], 64
  s_load_dwordx2 s[44:45], s[0:1], 80
  v_lshrrev_b32 v4, 3, v2
  v_and_b32 v5, 7, v2
  s_sub_u32 s20, s62, 10
  s_mul_i32 s20, s20, 20480
  s_add_u32 s20, s20, 5120
  s_mov_b32 s26, 1966080
  s_mov_b32 s27, 0x00020000
  s_mov_b32 s34, 1966080
  s_mov_b32 s35, 0x00020000
  s_cmp_eq_u32 s2, 255
  s_cbranch_scc1 F_ez
  s_cmp_eq_u32 s62, 11
  s_cbranch_scc1 F_wd
  s_cmp_lt_u32 s2, 63
  s_cbranch_scc1 F_send2
  s_sub_u32 s21, s2, 63
  s_and_b32 s22, s21, 7
  s_lshr_b32 s21, s21, 3
  s_mul_i32 s23, s22, 5
  s_waitcnt lgkmcnt(0)
  s_mov_b32 s24, s40
  s_mov_b32 s25, s41
  s_mov_b32 s32, s42
  s_mov_b32 s33, s43
  v_and_b32 v10, 2, v4
  v_xor_b32 v10, v10, v5
  v_mul_u32_u24 v11, 3072, v4
  v_lshl_add_u32 v10, v10, 4, v11
  v_xor_b32 v11, 64, v10
  s_mul_i32 s36, s23, 49152
  s_lshl_b32 s37, s21, 7
  s_add_u32 s36, s36, s37
  v_bfe_u32 v3, v2, 4, 1
  v_lshrrev_b32 v6, 5, v2
  v_bfe_u32 v7, v2, 2, 2
  v_and_b32 v8, 3, v2
  v_mul_u32_u24 v48, 2112, v3
  v_lshl_add_u32 v48, v6, 10, v48
  v_lshl_add_u32 v48, v7, 7, v48
  v_lshl_add_u32 v48, v8, 3, v48
  v_and_b32 v7, 2, v7
  v_lshl_add_u32 v48, v7, 4, v48
  v_add_u32 v48, s20, v48
  v_xor_b32 v49, 32, v48
  v_xor_b32 v50, 64, v48
  v_xor_b32 v51, 96, v48
  v_mov_b32 v52, 0
  v_mov_b32 v53, 0
  v_mov_b32 v54, 0
  v_mov_b32 v55, 0
  s_barrier
  s_barrier
  s_waitcnt vmcnt(0)
  s_barrier
  s_barrier
  s_add_u32 m0, s20, 0
  s_nop 0
  buffer_load_dwordx4 v10, s[24:27], s36 offen nt lds
  s_add_u32 m0, s20, 2048
  s_nop 0
  buffer_load_dwordx4 v11, s[32:35], s36 offen nt lds
  s_add_u32 s36, s36, 24576
  s_add_u32 m0, s20, 1024
  s_nop 0
  buffer_load_dwordx4 v10, s[24:27], s36 offen nt lds
  s_add_u32 m0, s20, 3072
  s_nop 0
  buffer_load_dwordx4 v11, s[32:35], s36 offen nt lds
  s_add_u32 s36, s36, 24576
  s_add_u32 m0, s20, 4096
  s_nop 0
  buffer_load_dwordx4 v10, s[24:27], s36 offen nt lds
  s_add_u32 m0, s20, 6144
  s_nop 0
  buffer_load_dwordx4 v11, s[32:35], s36 offen nt lds
  s_add_u32 s36, s36, 24576
  s_add_u32 m0, s20, 5120
  s_nop 0
  buffer_load_dwordx4 v10, s[24:27], s36 offen nt lds
  s_add_u32 m0, s20, 7168
  s_nop 0
  buffer_load_dwordx4 v11, s[32:35], s36 offen nt lds
  s_add_u32 s36, s36, 24576
  s_add_u32 m0, s20, 8192
  s_nop 0
  buffer_load_dwordx4 v10, s[24:27], s36 offen nt lds
  s_add_u32 m0, s20, 10240
  s_nop 0
  buffer_load_dwordx4 v11, s[32:35], s36 offen nt lds
  s_add_u32 s36, s36, 24576
  s_add_u32 m0, s20, 9216
  s_nop 0
  buffer_load_dwordx4 v10, s[24:27], s36 offen nt lds
  s_add_u32 m0, s20, 11264
  s_nop 0
  buffer_load_dwordx4 v11, s[32:35], s36 offen nt lds
  s_add_u32 s36, s36, 24576
  s_add_u32 m0, s20, 12288
  s_nop 0
  buffer_load_dwordx4 v10, s[24:27], s36 offen nt lds
  s_add_u32 m0, s20, 14336
  s_nop 0
  buffer_load_dwordx4 v11, s[32:35], s36 offen nt lds
  s_add_u32 s36, s36, 24576
  s_add_u32 m0, s20, 13312
  s_nop 0
  buffer_load_dwordx4 v10, s[24:27], s36 offen nt lds
  s_add_u32 m0, s20, 15360
  s_nop 0
  buffer_load_dwordx4 v11, s[32:35], s36 offen nt lds
  s_add_u32 s36, s36, 24576
  s_add_u32 m0, s20, 16384
  s_nop 0
  buffer_load_dwordx4 v10, s[24:27], s36 offen nt lds
  s_add_u32 m0, s20, 18432
  s_nop 0
  buffer_load_dwordx4 v11, s[32:35], s36 offen nt lds
  s_add_u32 s36, s36, 24576
  s_add_u32 m0, s20, 17408
  s_nop 0
  buffer_load_dwordx4 v10, s[24:27], s36 offen nt lds
  s_add_u32 m0, s20, 19456
  s_nop 0
  buffer_load_dwordx4 v11, s[32:35], s36 offen nt lds
  s_mul_i32 s47, s21, 167936
  s_lshl_b32 s36, s23, 10
  s_add_u32 s47, s47, 7208960
  s_add_u32 s36, s36, s47
  s_add_u32 s37, s36, 41984
  s_add_u32 s38, s37, 41984
  s_add_u32 s39, s38, 41984
  v_add_u32 v12, 4096, v9
  s_setprio 3
  s_waitcnt vmcnt(16)
  ds_read_b64_tr_b16 v[64:65], v48 offset:0
  ds_read_b64_tr_b16 v[66:67], v48 offset:512
  ds_read_b64_tr_b16 v[68:69], v49 offset:0
  ds_read_b64_tr_b16 v[70:71], v49 offset:512
  ds_read_b64_tr_b16 v[72:73], v50 offset:0
  ds_read_b64_tr_b16 v[74:75], v50 offset:512
  ds_read_b64_tr_b16 v[76:77], v51 offset:0
  ds_read_b64_tr_b16 v[78:79], v51 offset:512
  s_waitcnt vmcnt(12)
  ds_read_b64_tr_b16 v[80:81], v48 offset:4096
  ds_read_b64_tr_b16 v[82:83], v48 offset:4608
  ds_read_b64_tr_b16 v[84:85], v49 offset:4096
  ds_read_b64_tr_b16 v[86:87], v49 offset:4608
  ds_read_b64_tr_b16 v[88:89], v50 offset:4096
  ds_read_b64_tr_b16 v[90:91], v50 offset:4608
  ds_read_b64_tr_b16 v[92:93], v51 offset:4096
  ds_read_b64_tr_b16 v[94:95], v51 offset:4608
  s_waitcnt lgkmcnt(14)
  buffer_store_dwordx4 v[64:67], v9, s[4:7], s36 offen offset:0 sc1
  s_waitcnt lgkmcnt(12)
  buffer_store_dwordx4 v[68:71], v9, s[4:7], s37 offen offset:0 sc1
  s_waitcnt lgkmcnt(10)
  buffer_store_dwordx4 v[72:75], v9, s[4:7], s38 offen offset:0 sc1
  s_waitcnt lgkmcnt(8)
  buffer_store_dwordx4 v[76:79], v9, s[4:7], s39 offen offset:0 sc1
  s_waitcnt vmcnt(12)
  ds_read_b64_tr_b16 v[96:97], v48 offset:8192
  ds_read_b64_tr_b16 v[98:99], v48 offset:8704
  ds_read_b64_tr_b16 v[100:101], v49 offset:8192
  ds_read_b64_tr_b16 v[102:103], v49 offset:8704
  ds_read_b64_tr_b16 v[104:105], v50 offset:8192
  ds_read_b64_tr_b16 v[106:107], v50 offset:8704
  ds_read_b64_tr_b16 v[108:109], v51 offset:8192
  ds_read_b64_tr_b16 v[110:111], v51 offset:8704
  s_waitcnt lgkmcnt(14)
  buffer_store_dwordx4 v[80:83], v9, s[4:7], s36 offen offset:1024 sc1
  s_waitcnt lgkmcnt(12)
  buffer_store_dwordx4 v[84:87], v9, s[4:7], s37 offen offset:1024 sc1
  s_waitcnt lgkmcnt(10)
  buffer_store_dwordx4 v[88:91], v9, s[4:7], s38 offen offset:1024 sc1
  s_waitcnt lgkmcnt(8)
  buffer_store_dwordx4 v[92:95], v9, s[4:7], s39 offen offset:1024 sc1
  s_waitcnt vmcnt(12)
  ds_read_b64_tr_b16 v[112:113], v48 offset:12288
  ds_read_b64_tr_b16 v[114:115], v48 offset:12800
  ds_read_b64_tr_b16 v[116:117], v49 offset:12288
  ds_read_b64_tr_b16 v[118:119], v49 offset:12800
  ds_read_b64_tr_b16 v[120:121], v50 offset:12288
  ds_read_b64_tr_b16 v[122:123], v50 offset:12800
  ds_read_b64_tr_b16 v[124:125], v51 offset:12288
  ds_read_b64_tr_b16 v[126:127], v51 offset:12800
  s_waitcnt lgkmcnt(14)
  buffer_store_dwordx4 v[96:99], v9, s[4:7], s36 offen offset:2048 sc1
  s_waitcnt lgkmcnt(12)
  buffer_store_dwordx4 v[100:103], v9, s[4:7], s37 offen offset:2048 sc1
  s_waitcnt lgkmcnt(10)
  buffer_store_dwordx4 v[104:107], v9, s[4:7], s38 offen offset:2048 sc1
  s_waitcnt lgkmcnt(8)
  buffer_store_dwordx4 v[108:111], v9, s[4:7], s39 offen offset:2048 sc1
  s_waitcnt vmcnt(12)
  ds_read_b64_tr_b16 v[128:129], v48 offset:16384
  ds_read_b64_tr_b16 v[130:131], v48 offset:16896
  ds_read_b64_tr_b16 v[132:133], v49 offset:16384
  ds_read_b64_tr_b16 v[134:135], v49 offset:16896
  ds_read_b64_tr_b16 v[136:137], v50 offset:16384
  ds_read_b64_tr_b16 v[138:139], v50 offset:16896
  ds_read_b64_tr_b16 v[140:141], v51 offset:16384
  ds_read_b64_tr_b16 v[142:143], v51 offset:16896
  s_waitcnt lgkmcnt(14)
  buffer_store_dwordx4 v[112:115], v9, s[4:7], s36 offen offset:3072 sc1
  s_waitcnt lgkmcnt(12)
  buffer_store_dwordx4 v[116:119], v9, s[4:7], s37 offen offset:3072 sc1
  s_waitcnt lgkmcnt(10)
  buffer_store_dwordx4 v[120:123], v9, s[4:7], s38 offen offset:3072 sc1
  s_waitcnt lgkmcnt(8)
  buffer_store_dwordx4 v[124:127], v9, s[4:7], s39 offen offset:3072 sc1
  s_waitcnt lgkmcnt(6)
  buffer_store_dwordx4 v[128:131], v12, s[4:7], s36 offen offset:0 sc1
  s_waitcnt lgkmcnt(4)
  buffer_store_dwordx4 v[132:135], v12, s[4:7], s37 offen offset:0 sc1
  s_waitcnt lgkmcnt(2)
  buffer_store_dwordx4 v[136:139], v12, s[4:7], s38 offen offset:0 sc1
  s_waitcnt lgkmcnt(0)
  buffer_store_dwordx4 v[140:143], v12, s[4:7], s39 offen offset:0 sc1
  v_dot2c_f32_bf16 v52, s30, v64
  v_dot2c_f32_bf16 v53, s30, v68
  v_dot2c_f32_bf16 v54, s30, v72
  v_dot2c_f32_bf16 v55, s30, v76
  v_dot2c_f32_bf16 v52, s30, v65
  v_dot2c_f32_bf16 v53, s30, v69
  v_dot2c_f32_bf16 v54, s30, v73
  v_dot2c_f32_bf16 v55, s30, v77
  v_dot2c_f32_bf16 v52, s30, v66
  v_dot2c_f32_bf16 v53, s30, v70
  v_dot2c_f32_bf16 v54, s30, v74
  v_dot2c_f32_bf16 v55, s30, v78
  v_dot2c_f32_bf16 v52, s30, v67
  v_dot2c_f32_bf16 v53, s30, v71
  v_dot2c_f32_bf16 v54, s30, v75
  v_dot2c_f32_bf16 v55, s30, v79
  v_dot2c_f32_bf16 v52, s30, v80
  v_dot2c_f32_bf16 v53, s30, v84
  v_dot2c_f32_bf16 v54, s30, v88
  v_dot2c_f32_bf16 v55, s30, v92
  v_dot2c_f32_bf16 v52, s30, v81
  v_dot2c_f32_bf16 v53, s30, v85
  v_dot2c_f32_bf16 v54, s30, v89
  v_dot2c_f32_bf16 v55, s30, v93
  v_dot2c_f32_bf16 v52, s30, v82
  v_dot2c_f32_bf16 v53, s30, v86
  v_dot2c_f32_bf16 v54, s30, v90
  v_dot2c_f32_bf16 v55, s30, v94
  v_dot2c_f32_bf16 v52, s30, v83
  v_dot2c_f32_bf16 v53, s30, v87
  v_dot2c_f32_bf16 v54, s30, v91
  v_dot2c_f32_bf16 v55, s30, v95
  v_dot2c_f32_bf16 v52, s30, v96
  v_dot2c_f32_bf16 v53, s30, v100
  v_dot2c_f32_bf16 v54, s30, v104
  v_dot2c_f32_bf16 v55, s30, v108
  v_dot2c_f32_bf16 v52, s30, v97
  v_dot2c_f32_bf16 v53, s30, v101
  v_dot2c_f32_bf16 v54, s30, v105
  v_dot2c_f32_bf16 v55, s30, v109
  v_dot2c_f32_bf16 v52, s30, v98
  v_dot2c_f32_bf16 v53, s30, v102
  v_dot2c_f32_bf16 v54, s30, v106
  v_dot2c_f32_bf16 v55, s30, v110
  v_dot2c_f32_bf16 v52, s30, v99
  v_dot2c_f32_bf16 v53, s30, v103
  v_dot2c_f32_bf16 v54, s30, v107
  v_dot2c_f32_bf16 v55, s30, v111
  v_dot2c_f32_bf16 v52, s30, v112
  v_dot2c_f32_bf16 v53, s30, v116
  v_dot2c_f32_bf16 v54, s30, v120
  v_dot2c_f32_bf16 v55, s30, v124
  v_dot2c_f32_bf16 v52, s30, v113
  v_dot2c_f32_bf16 v53, s30, v117
  v_dot2c_f32_bf16 v54, s30, v121
  v_dot2c_f32_bf16 v55, s30, v125
  v_dot2c_f32_bf16 v52, s30, v114
  v_dot2c_f32_bf16 v53, s30, v118
  v_dot2c_f32_bf16 v54, s30, v122
  v_dot2c_f32_bf16 v55, s30, v126
  v_dot2c_f32_bf16 v52, s30, v115
  v_dot2c_f32_bf16 v53, s30, v119
  v_dot2c_f32_bf16 v54, s30, v123
  v_dot2c_f32_bf16 v55, s30, v127
  v_dot2c_f32_bf16 v52, s30, v128
  v_dot2c_f32_bf16 v53, s30, v132
  v_dot2c_f32_bf16 v54, s30, v136
  v_dot2c_f32_bf16 v55, s30, v140
  v_dot2c_f32_bf16 v52, s30, v129
  v_dot2c_f32_bf16 v53, s30, v133
  v_dot2c_f32_bf16 v54, s30, v137
  v_dot2c_f32_bf16 v55, s30, v141
  v_dot2c_f32_bf16 v52, s30, v130
  v_dot2c_f32_bf16 v53, s30, v134
  v_dot2c_f32_bf16 v54, s30, v138
  v_dot2c_f32_bf16 v55, s30, v142
  v_dot2c_f32_bf16 v52, s30, v131
  v_dot2c_f32_bf16 v53, s30, v135
  v_dot2c_f32_bf16 v54, s30, v139
  v_dot2c_f32_bf16 v55, s30, v143
  v_and_b32 v4, 31, v2
  v_lshlrev_b32 v4, 4, v4
  v_mul_u32_u24 v5, 41984, v6
  v_add_u32 v4, v4, v5
  s_lshr_b32 s36, s22, 2
  s_lshl_b32 s36, s36, 9
  s_and_b32 s37, s22, 3
  s_lshl_b32 s37, s37, 2
  s_add_u32 s36, s36, s37
  s_add_u32 s36, s36, s47
  s_add_u32 s36, s36, 40960
  s_add_u32 s37, s36, 83968
  v_permlane32_swap_b32 v52, v53
  v_add_f32 v52, v52, v53
  v_cvt_pk_bf16_f32 v53, v52, v52
  v_and_b32 v53, 0xffff0000, v53
  v_sub_f32 v52, v52, v53
  v_cvt_pk_bf16_f32 v52, v53, v52
  buffer_store_dword v52, v4, s[4:7], s36 offen
  v_permlane32_swap_b32 v54, v55
  v_add_f32 v54, v54, v55
  v_cvt_pk_bf16_f32 v55, v54, v54
  v_and_b32 v55, 0xffff0000, v55
  v_sub_f32 v54, v54, v55
  v_cvt_pk_bf16_f32 v54, v55, v54
  buffer_store_dword v54, v4, s[4:7], s37 offen
F_send2:
  s_waitcnt vmcnt(0)
  s_endpgm
F_wd:
  s_cmp_lt_u32 s2, 15
  s_cbranch_scc1 F_send2
  s_waitcnt lgkmcnt(0)
  s_mov_b32 s24, s44
  s_mov_b32 s25, s45
  s_mov_b32 s39, 11239424
  v_and_b32 v10, 2, v4
  v_lshlrev_b32 v10, 1, v10
  v_bfe_u32 v11, v4, 2, 1
  v_lshl_add_u32 v10, v11, 1, v10
  v_xor_b32 v10, v10, v5
  v_mul_u32_u24 v11, 1280, v4
  v_lshl_add_u32 v10, v10, 4, v11
  s_sub_u32 s21, s2, 15
  s_mul_i32 s50, s21, 13108
  s_lshr_b32 s50, s50, 16
  s_mul_i32 s23, s50, 5
  s_sub_u32 s51, s21, s23
  s_lshl_b32 s51, s51, 1
  s_mul_i32 s36, s50, 40960
  s_lshl_b32 s37, s51, 7
  s_add_u32 s36, s36, s37
  v_bfe_u32 v7, v2, 2, 2
  v_and_b32 v8, 3, v2
  v_lshrrev_b32 v6, 5, v2
  v_bfe_u32 v3, v2, 4, 1
  v_lshlrev_b32 v48, 11, v6
  v_lshl_add_u32 v48, v3, 9, v48
  v_lshl_add_u32 v48, v7, 7, v48
  v_add_u32 v48, s20, v48
  v_and_b32 v7, 2, v7
  v_lshlrev_b32 v7, 5, v7
  v_lshl_add_u32 v7, v3, 5, v7
  s_barrier
  s_barrier
  s_waitcnt vmcnt(0)
  s_barrier
  s_barrier
  s_add_u32 m0, s20, 0
  s_nop 0
  buffer_load_dwordx4 v10, s[24:27], s36 offen offset:0 nt lds
  s_add_u32 m0, s20, 3968
  s_nop 0
  buffer_load_dwordx4 v10, s[24:27], s36 offen offset:128 nt lds
  s_add_u32 s36, s36, 10240
  s_add_u32 m0, s20, 1024
  s_nop 0
  buffer_load_dwordx4 v10, s[24:27], s36 offen offset:0 nt lds
  s_add_u32 m0, s20, 4992
  s_nop 0
  buffer_load_dwordx4 v10, s[24:27], s36 offen offset:128 nt lds
  s_add_u32 s36, s36, 10240
  s_add_u32 m0, s20, 2048
  s_nop 0
  buffer_load_dwordx4 v10, s[24:27], s36 offen offset:0 nt lds
  s_add_u32 m0, s20, 6016
  s_nop 0
  buffer_load_dwordx4 v10, s[24:27], s36 offen offset:128 nt lds
  s_add_u32 s36, s36, 10240
  s_add_u32 m0, s20, 3072
  s_nop 0
  buffer_load_dwordx4 v10, s[24:27], s36 offen offset:0 nt lds
  s_add_u32 m0, s20, 7040
  s_nop 0
  buffer_load_dwordx4 v10, s[24:27], s36 offen offset:128 nt lds
  s_lshl_b32 s36, s51, 1
  s_add_u32 s36, s36, 0
  s_mul_i32 s37, s36, 52
  s_lshr_b32 s37, s37, 8
  s_mul_i32 s37, s37, 5
  s_sub_u32 s36, s36, s37
  s_cmp_eq_u32 s36, 2
  s_cselect_b32 s36, 3, 4
  s_cselect_b32 s37, 32, 8
  v_lshlrev_b32 v49, s36, v8
  v_add_u32 v49, 0, v49
  v_add_u32 v50, s37, v49
  v_xor_b32 v49, v49, v7
  v_xor_b32 v50, v50, v7
  v_add_u32 v49, v49, v48
  v_add_u32 v50, v50, v48
  s_lshl_b32 s36, s51, 1
  s_add_u32 s36, s36, 1
  s_mul_i32 s37, s36, 52
  s_lshr_b32 s37, s37, 8
  s_mul_i32 s37, s37, 5
  s_sub_u32 s36, s36, s37
  s_cmp_eq_u32 s36, 2
  s_cselect_b32 s36, 3, 4
  s_cselect_b32 s37, 32, 8
  v_lshlrev_b32 v51, s36, v8
  v_add_u32 v51, 64, v51
  v_add_u32 v52, s37, v51
  v_xor_b32 v51, v51, v7
  v_xor_b32 v52, v52, v7
  v_add_u32 v51, v51, v48
  v_add_u32 v52, v52, v48
  s_lshl_b32 s36, s51, 2
  s_add_u32 s36, s36, 0
  s_mul_i32 s37, s36, 52
  s_lshr_b32 s37, s37, 8
  s_mul_i32 s38, s37, 5
  s_sub_u32 s36, s36, s38
  s_and_b32 s38, s37, 1
  s_sub_u32 s36, s36, s38
  s_cselect_b32 s36, 4, s36
  s_mul_i32 s37, s37, 48
  s_add_u32 s37, s37, s50
  s_mul_i32 s37, s37, 5
  s_add_u32 s37, s37, s36
  s_lshl_b32 s37, s37, 10
  s_add_u32 s52, s37, s39
  s_lshl_b32 s36, s51, 2
  s_add_u32 s36, s36, 1
  s_mul_i32 s37, s36, 52
  s_lshr_b32 s37, s37, 8
  s_mul_i32 s38, s37, 5
  s_sub_u32 s36, s36, s38
  s_and_b32 s38, s37, 1
  s_sub_u32 s36, s36, s38
  s_cselect_b32 s36, 4, s36
  s_mul_i32 s37, s37, 48
  s_add_u32 s37, s37, s50
  s_mul_i32 s37, s37, 5
  s_add_u32 s37, s37, s36
  s_lshl_b32 s37, s37, 10
  s_add_u32 s53, s37, s39
  s_lshl_b32 s36, s51, 2
  s_add_u32 s36, s36, 2
  s_mul_i32 s37, s36, 52
  s_lshr_b32 s37, s37, 8
  s_mul_i32 s38, s37, 5
  s_sub_u32 s36, s36, s38
  s_and_b32 s38, s37, 1
  s_sub_u32 s36, s36, s38
  s_cselect_b32 s36, 4, s36
  s_mul_i32 s37, s37, 48
  s_add_u32 s37, s37, s50
  s_mul_i32 s37, s37, 5
  s_add_u32 s37, s37, s36
  s_lshl_b32 s37, s37, 10
  s_add_u32 s54, s37, s39
  s_lshl_b32 s36, s51, 2
  s_add_u32 s36, s36, 3
  s_mul_i32 s37, s36, 52
  s_lshr_b32 s37, s37, 8
  s_mul_i32 s38, s37, 5
  s_sub_u32 s36, s36, s38
  s_and_b32 s38, s37, 1
  s_sub_u32 s36, s36, s38
  s_cselect_b32 s36, 4, s36
  s_mul_i32 s37, s37, 48
  s_add_u32 s37, s37, s50
  s_mul_i32 s37, s37, 5
  s_add_u32 s37, s37, s36
  s_lshl_b32 s37, s37, 10
  s_add_u32 s55, s37, s39
  s_lshl_b32 s36, s51, 1
  s_add_u32 s36, s36, 2
  s_mul_i32 s37, s36, 52
  s_lshr_b32 s37, s37, 8
  s_mul_i32 s37, s37, 5
  s_sub_u32 s36, s36, s37
  s_cmp_eq_u32 s36, 2
  s_cselect_b32 s36, 3, 4
  s_cselect_b32 s37, 32, 8
  v_lshlrev_b32 v53, s36, v8
  v_add_u32 v53, 0, v53
  v_add_u32 v54, s37, v53
  v_xor_b32 v53, v53, v7
  v_xor_b32 v54, v54, v7
  v_add_u32 v53, v53, v48
  v_add_u32 v54, v54, v48
  s_lshl_b32 s36, s51, 1
  s_add_u32 s36, s36, 3
  s_mul_i32 s37, s36, 52
  s_lshr_b32 s37, s37, 8
  s_mul_i32 s37, s37, 5
  s_sub_u32 s36, s36, s37
  s_cmp_eq_u32 s36, 2
  s_cselect_b32 s36, 3, 4
  s_cselect_b32 s37, 32, 8
  v_lshlrev_b32 v55, s36, v8
  v_add_u32 v55, 64, v55
  v_add_u32 v56, s37, v55
  v_xor_b32 v55, v55, v7
  v_xor_b32 v56, v56, v7
  v_add_u32 v55, v55, v48
  v_add_u32 v56, v56, v48
  s_lshl_b32 s36, s51, 2
  s_add_u32 s36, s36, 4
  s_mul_i32 s37, s36, 52
  s_lshr_b32 s37, s37, 8
  s_mul_i32 s38, s37, 5
  s_sub_u32 s36, s36, s38
  s_and_b32 s38, s37, 1
  s_sub_u32 s36, s36, s38
  s_cselect_b32 s36, 4, s36
  s_mul_i32 s37, s37, 48
  s_add_u32 s37, s37, s50
  s_mul_i32 s37, s37, 5
  s_add_u32 s37, s37, s36
  s_lshl_b32 s37, s37, 10
  s_add_u32 s56, s37, s39
  s_lshl_b32 s36, s51, 2
  s_add_u32 s36, s36, 5
  s_mul_i32 s37, s36, 52
  s_lshr_b32 s37, s37, 8
  s_mul_i32 s38, s37, 5
  s_sub_u32 s36, s36, s38
  s_and_b32 s38, s37, 1
  s_sub_u32 s36, s36, s38
  s_cselect_b32 s36, 4, s36
  s_mul_i32 s37, s37, 48
  s_add_u32 s37, s37, s50
  s_mul_i32 s37, s37, 5
  s_add_u32 s37, s37, s36
  s_lshl_b32 s37, s37, 10
  s_add_u32 s57, s37, s39
  s_lshl_b32 s36, s51, 2
  s_add_u32 s36, s36, 6
  s_mul_i32 s37, s36, 52
  s_lshr_b32 s37, s37, 8
  s_mul_i32 s38, s37, 5
  s_sub_u32 s36, s36, s38
  s_and_b32 s38, s37, 1
  s_sub_u32 s36, s36, s38
  s_cselect_b32 s36, 4, s36
  s_mul_i32 s37, s37, 48
  s_add_u32 s37, s37, s50
  s_mul_i32 s37, s37, 5
  s_add_u32 s37, s37, s36
  s_lshl_b32 s37, s37, 10
  s_add_u32 s58, s37, s39
  s_lshl_b32 s36, s51, 2
  s_add_u32 s36, s36, 7
  s_mul_i32 s37, s36, 52
  s_lshr_b32 s37, s37, 8
  s_mul_i32 s38, s37, 5
  s_sub_u32 s36, s36, s38
  s_and_b32 s38, s37, 1
  s_sub_u32 s36, s36, s38
  s_cselect_b32 s36, 4, s36
  s_mul_i32 s37, s37, 48
  s_add_u32 s37, s37, s50
  s_mul_i32 s37, s37, 5
  s_add_u32 s37, s37, s36
  s_lshl_b32 s37, s37, 10
  s_add_u32 s59, s37, s39
  s_setprio 3
  s_waitcnt vmcnt(0)
  ds_read_b64_tr_b16 v[64:65], v49 offset:0
  ds_read_b64_tr_b16 v[66:67], v49 offset:1024
  ds_read_b64_tr_b16 v[68:69], v50 offset:0
  ds_read_b64_tr_b16 v[70:71], v50 offset:1024
  ds_read_b64_tr_b16 v[72:73], v51 offset:0
  ds_read_b64_tr_b16 v[74:75], v51 offset:1024
  ds_read_b64_tr_b16 v[76:77], v52 offset:0
  ds_read_b64_tr_b16 v[78:79], v52 offset:1024
  ds_read_b64_tr_b16 v[80:81], v53 offset:4096
  ds_read_b64_tr_b16 v[82:83], v53 offset:5120
  ds_read_b64_tr_b16 v[84:85], v54 offset:4096
  ds_read_b64_tr_b16 v[86:87], v54 offset:5120
  ds_read_b64_tr_b16 v[88:89], v55 offset:4096
  ds_read_b64_tr_b16 v[90:91], v55 offset:5120
  ds_read_b64_tr_b16 v[92:93], v56 offset:4096
  ds_read_b64_tr_b16 v[94:95], v56 offset:5120
  s_waitcnt lgkmcnt(14)
  buffer_store_dwordx4 v[64:67], v9, s[4:7], s52 offen sc1
  s_waitcnt lgkmcnt(12)
  buffer_store_dwordx4 v[68:71], v9, s[4:7], s53 offen sc1
  s_waitcnt lgkmcnt(10)
  buffer_store_dwordx4 v[72:75], v9, s[4:7], s54 offen sc1
  s_waitcnt lgkmcnt(8)
  buffer_store_dwordx4 v[76:79], v9, s[4:7], s55 offen sc1
  s_waitcnt lgkmcnt(6)
  buffer_store_dwordx4 v[80:83], v9, s[4:7], s56 offen sc1
  s_waitcnt lgkmcnt(4)
  buffer_store_dwordx4 v[84:87], v9, s[4:7], s57 offen sc1
  s_waitcnt lgkmcnt(2)
  buffer_store_dwordx4 v[88:91], v9, s[4:7], s58 offen sc1
  s_waitcnt lgkmcnt(0)
  buffer_store_dwordx4 v[92:95], v9, s[4:7], s59 offen sc1
  s_endpgm
F_end:
  s_endpgm
.p2align 7
A_tab:
.long 0x06000600
.long 0x06000600
.long 0x06000600
.long 0x06000600
.long 0x06000600
.long 0x06000600
.long 0x06000600
.long 0x06000600
.long 0x06000600
.long 0x06000600
.long 0x06000600
.long 0x06000600
.long 0x06000600
.long 0x06000600
.long 0x00800600
.long 0x00800080
.long 0x04780080
.long 0x02f802f8
.long 0x03f802f8
.long 0x007e007e
.long 0x0470007e
.long 0x02f002f0
.long 0x03f002f0
.long 0x00760076
.long 0x04680076
.long 0x02e802e8
.long 0x03e802e8
.long 0x006e006e
.long 0x0460006e
.long 0x02e002e0
.long 0x03e002e0
.long 0x00660066
.long 0x04580066
.long 0x02d802d8
.long 0x03d802d8
.long 0x005e005e
.long 0x0450005e
.long 0x02d002d0
.long 0x03d002d0
.long 0x00560056
.long 0x04480056
.long 0x02c802c8
.long 0x03c802c8
.long 0x004e004e
.long 0x0440004e
.long 0x02c002c0
.long 0x03c002c0
.long 0x00460046
.long 0x04380046
.long 0x02b802b8
.long 0x03b802b8
.long 0x003e003e
.long 0x0430003e
.long 0x02b002b0
.long 0x03b002b0
.long 0x00360036
.long 0x04280036
.long 0x02a802a8
.long 0x03a802a8
.long 0x002e002e
.long 0x0420002e
.long 0x02a002a0
.long 0x03a002a0
.long 0x00260026
.long 0x04180026
.long 0x02980298
.long 0x03980298
.long 0x001e001e
.long 0x0410001e
.long 0x02900290
.long 0x03900290
.long 0x00160016
.long 0x04080016
.long 0x02880288
.long 0x03880288
.long 0x000e000e
.long 0x0400000e
.long 0x02800280
.long 0x03800280
.long 0x00060006
.long 0x03fe0006
.long 0x027e027e
.long 0x037e027e
.long 0x007c007c
.long 0x03f6007c
.long 0x02760276
.long 0x03760276
.long 0x00740074
.long 0x03ee0074
.long 0x026e026e
.long 0x036e026e
.long 0x006c006c
.long 0x03e6006c
.long 0x02660266
.long 0x03660266
.long 0x00640064
.long 0x03de0064
.long 0x025e025e
.long 0x035e025e
.long 0x005c005c
.long 0x03d6005c
.long 0x02560256
.long 0x03560256
.long 0x00540054
.long 0x03ce0054
.long 0x024e024e
.long 0x034e024e
.long 0x004c004c
.long 0x03c6004c
.long 0x02460246
.long 0x03460246
.long 0x00440044
.long 0x03be0044
.long 0x023e023e
.long 0x033e023e
.long 0x003c003c
.long 0x03b6003c
.long 0x02360236
.long 0x03360236
.long 0x00340034
.long 0x03ae0034
.long 0x022e022e
.long 0x032e022e
.long 0x002c002c
.long 0x03a6002c
.long 0x02260226
.long 0x03260226
.long 0x00240024
.long 0x039e0024
.long 0x021e021e
.long 0x031e021e
.long 0x001c001c
.long 0x0396001c
.long 0x02160216
.long 0x03160216
.long 0x00140014
.long 0x038e0014
.long 0x020e020e
.long 0x030e020e
.long 0x000c000c
.long 0x0386000c
.long 0x02060206
.long 0x03060206
.long 0x00040004
.long 0x03fc0578
.long 0x027c04fe
.long 0x037c04fc
.long 0x007a04fa
.long 0x03f40570
.long 0x027404f6
.long 0x037404f4
.long 0x007204f2
.long 0x03ec0568
.long 0x026c04ee
.long 0x036c04ec
.long 0x006a04ea
.long 0x03e40560
.long 0x026404e6
.long 0x036404e4
.long 0x006204e2
.long 0x03dc0558
.long 0x025c04de
.long 0x035c04dc
.long 0x005a04da
.long 0x03d40550
.long 0x025404d6
.long 0x035404d4
.long 0x005204d2
.long 0x03cc0548
.long 0x024c04ce
.long 0x034c04cc
.long 0x004a04ca
.long 0x03c40540
.long 0x024404c6
.long 0x034404c4
.long 0x004204c2
.long 0x03bc0538
.long 0x023c04be
.long 0x033c04bc
.long 0x003a04ba
.long 0x03b40530
.long 0x023404b6
.long 0x033404b4
.long 0x003204b2
.long 0x03ac0528
.long 0x022c04ae
.long 0x032c04ac
.long 0x002a04aa
.long 0x03a40520
.long 0x022404a6
.long 0x032404a4
.long 0x002204a2
.long 0x039c0518
.long 0x021c049e
.long 0x031c049c
.long 0x001a049a
.long 0x03940510
.long 0x02140496
.long 0x03140494
.long 0x00120492
.long 0x038c0508
.long 0x020c048e
.long 0x030c048c
.long 0x000a048a
.long 0x03840500
.long 0x02040486
.long 0x03040484
.long 0x00020482
.long 0x03fa04f8
.long 0x027a047e
.long 0x037a047c
.long 0x0078047a
.long 0x03f204f0
.long 0x02720476
.long 0x03720474
.long 0x00700472
.long 0x03ea04e8
.long 0x026a046e
.long 0x036a046c
.long 0x0068046a
.long 0x03e204e0
.long 0x02620466
.long 0x03620464
.long 0x00600462
.long 0x03da04d8
.long 0x025a045e
.long 0x035a045c
.long 0x0058045a
.long 0x03d204d0
.long 0x02520456
.long 0x03520454
.long 0x00500452
.long 0x03ca04c8
.long 0x024a044e
.long 0x034a044c
.long 0x0048044a
.long 0x03c204c0
.long 0x02420446
.long 0x03420444
.long 0x00400442
.long 0x03ba04b8
.long 0x023a043e
.long 0x033a043c
.long 0x0038043a
.long 0x03b204b0
.long 0x02320436
.long 0x03320434
.long 0x00300432
.long 0x03aa04a8
.long 0x022a042e
.long 0x032a042c
.long 0x0028042a
.long 0x03a204a0
.long 0x02220426
.long 0x03220424
.long 0x00200422
.long 0x039a0498
.long 0x021a041e
.long 0x031a041c
.long 0x0018041a
.long 0x03920490
.long 0x02120416
.long 0x03120414
.long 0x00100412
.long 0x038a0488
.long 0x020a040e
.long 0x030a040c
.long 0x0008040a
.long 0x03820480
.long 0x02020406
.long 0x03020404
.long 0x00000402
.long 0x06000600
.long 0x06000600
.long 0x06000600
.long 0x06000600
.long 0x06000600
.long 0x06000600
.long 0x06000600
.long 0x06000600
.long 0x020001fe
.long 0x01f601ee
.long 0x01e601de
.long 0x01d601ce
.long 0x01c601be
.long 0x01b601ae
.long 0x01a6019e
.long 0x0196018e
.long 0x018601fc
.long 0x01f401ec
.long 0x01e401dc
.long 0x01d401cc
.long 0x01c401bc
.long 0x01b401ac
.long 0x01a4019c
.long 0x0194018c
.long 0x018401fa
.long 0x01f201ea
.long 0x01e201da
.long 0x01d201ca
.long 0x01c201ba
.long 0x01b201aa
.long 0x01a2019a
.long 0x0192018a
.long 0x018201f8
.long 0x01f001e8
.long 0x01e001d8
.long 0x01d001c8
.long 0x01c001b8
.long 0x01b001a8
.long 0x01a00198
.long 0x01900188
.long 0x0180017e
.long 0x0176016e
.long 0x0166015e
.long 0x0156014e
.long 0x0146013e
.long 0x0136012e
.long 0x0126011e
.long 0x0116010e
.long 0x0106017c
.long 0x0174016c
.long 0x0164015c
.long 0x0154014c
.long 0x0144013c
.long 0x0134012c
.long 0x0124011c
.long 0x0114010c
.long 0x0104017a
.long 0x0172016a
.long 0x0162015a
.long 0x0152014a
.long 0x0142013a
.long 0x0132012a
.long 0x0122011a
.long 0x0112010a
.long 0x01020178
.long 0x01700168
.long 0x01600158
.long 0x01500148
.long 0x01400138
.long 0x01300128
.long 0x01200118
.long 0x01100108
.long 0x06000600
.long 0x06000600
.long 0x06000600
.long 0x06000600
.long 0x06000600
.long 0x06000600
.long 0x06000600
.long 0x06000600
.long 0x06000600
.long 0x06000600
.long 0x06000600
.long 0x06000600
.long 0x06000600
.long 0x06000600
.long 0x06000600
.long 0x06000600
.long 0x00fe0370
.long 0x00ee0360
.long 0x00de0350
.long 0x00ce0340
.long 0x00be0330
.long 0x00ae0320
.long 0x009e0310
.long 0x008e0300
.long 0x00fc02f6
.long 0x00ec02e6
.long 0x00dc02d6
.long 0x00cc02c6
.long 0x00bc02b6
.long 0x00ac02a6
.long 0x009c0296
.long 0x008c0286
.long 0x00fa02f4
.long 0x00ea02e4
.long 0x00da02d4
.long 0x00ca02c4
.long 0x00ba02b4
.long 0x00aa02a4
.long 0x009a0294
.long 0x008a0284
.long 0x00f802f2
.long 0x00e802e2
.long 0x00d802d2
.long 0x00c802c2
.long 0x00b802b2
.long 0x00a802a2
.long 0x00980292
.long 0x00880282
.long 0x06000600
.long 0x06000600
.long 0x06000600
.long 0x06000600
.long 0x06000600
.long 0x06000600
.long 0x06000600
.long 0x06000600
.long 0x06000600
.long 0x06000600
.long 0x06000600
.long 0x06000600
.long 0x06000600
.long 0x06000600
.long 0x06000600
.long 0x06000600
.long 0x01000378
.long 0x00f60368
.long 0x00e60358
.long 0x00d60348
.long 0x00c60338
.long 0x00b60328
.long 0x00a60318
.long 0x00960308
.long 0x008602fe
.long 0x00f402ee
.long 0x00e402de
.long 0x00d402ce
.long 0x00c402be
.long 0x00b402ae
.long 0x00a4029e
.long 0x0094028e
.long 0x008402fc
.long 0x00f202ec
.long 0x00e202dc
.long 0x00d202cc
.long 0x00c202bc
.long 0x00b202ac
.long 0x00a2029c
.long 0x0092028c
.long 0x008202fa
.long 0x00f002ea
.long 0x00e002da
.long 0x00d002ca
.long 0x00c002ba
.long 0x00b002aa
.long 0x00a0029a
.long 0x0090028a
.long 0x06000600
.long 0x06000600
.long 0x06000600
.long 0x06000600
.long 0x06000600
.long 0x06000600
.long 0x06000600
.long 0x06000600
.long 0x06000600
.long 0x06000600
.long 0x06000600
.long 0x06000600
.long 0x06000600
.long 0x06000600
.long 0x06000600
.long 0x06000600
.long 0x01000100
.long 0x06000600
.long 0x06000600
.long 0x06000600
.long 0x06000600
.long 0x06000600
.long 0x06000600
.long 0x06000600
.long 0x06000600
.long 0x06000600
.long 0x06000600
.long 0x06000600
.long 0x06000600
.long 0x06000600
.long 0x06000600
.long 0x06000600
.long 0x06000600
.long 0x06000600
.long 0x06000600
.long 0x06000600
.long 0x06000600
.long 0x06000600
.long 0x00800080
.long 0x00800080
.long 0x02f80478
.long 0x02f802f8
.long 0x007e03f8
.long 0x007e007e
.long 0x02f00470
.long 0x02f002f0
.long 0x007603f0
.long 0x00760076
.long 0x02e80468
.long 0x02e802e8
.long 0x006e03e8
.long 0x006e006e
.long 0x02e00460
.long 0x02e002e0
.long 0x006603e0
.long 0x00660066
.long 0x02d80458
.long 0x02d802d8
.long 0x005e03d8
.long 0x005e005e
.long 0x02d00450
.long 0x02d002d0
.long 0x005603d0
.long 0x00560056
.long 0x02c80448
.long 0x02c802c8
.long 0x004e03c8
.long 0x004e004e
.long 0x02c00440
.long 0x02c002c0
.long 0x004603c0
.long 0x00460046
.long 0x02b80438
.long 0x02b802b8
.long 0x003e03b8
.long 0x003e003e
.long 0x02b00430
.long 0x02b002b0
.long 0x003603b0
.long 0x00360036
.long 0x02a80428
.long 0x02a802a8
.long 0x002e03a8
.long 0x002e002e
.long 0x02a00420
.long 0x02a002a0
.long 0x002603a0
.long 0x00260026
.long 0x02980418
.long 0x02980298
.long 0x001e0398
.long 0x001e001e
.long 0x02900410
.long 0x02900290
.long 0x00160390
.long 0x00160016
.long 0x02880408
.long 0x02880288
.long 0x000e0388
.long 0x000e000e
.long 0x02800400
.long 0x02800280
.long 0x00060380
.long 0x00060006
.long 0x027e03fe
.long 0x027e027e
.long 0x007c037e
.long 0x007c007c
.long 0x027603f6
.long 0x02760276
.long 0x00740376
.long 0x00740074
.long 0x026e03ee
.long 0x026e026e
.long 0x006c036e
.long 0x006c006c
.long 0x026603e6
.long 0x02660266
.long 0x00640366
.long 0x00640064
.long 0x025e03de
.long 0x025e025e
.long 0x005c035e
.long 0x005c005c
.long 0x025603d6
.long 0x02560256
.long 0x00540356
.long 0x00540054
.long 0x024e03ce
.long 0x024e024e
.long 0x004c034e
.long 0x004c004c
.long 0x024603c6
.long 0x02460246
.long 0x00440346
.long 0x00440044
.long 0x023e03be
.long 0x023e023e
.long 0x003c033e
.long 0x003c003c
.long 0x023603b6
.long 0x02360236
.long 0x00340336
.long 0x00340034
.long 0x022e03ae
.long 0x022e022e
.long 0x002c032e
.long 0x002c002c
.long 0x022603a6
.long 0x02260226
.long 0x00240326
.long 0x00240024
.long 0x021e039e
.long 0x021e021e
.long 0x001c031e
.long 0x001c001c
.long 0x02160396
.long 0x02160216
.long 0x00140316
.long 0x00140014
.long 0x020e038e
.long 0x020e020e
.long 0x000c030e
.long 0x000c000c
.long 0x02060386
.long 0x02060206
.long 0x00040306
.long 0x05780004
.long 0x04fe03fc
.long 0x04fc027c
.long 0x04fa037c
.long 0x0570007a
.long 0x04f603f4
.long 0x04f40274
.long 0x04f20374
.long 0x05680072
.long 0x04ee03ec
.long 0x04ec026c
.long 0x04ea036c
.long 0x0560006a
.long 0x04e603e4
.long 0x04e40264
.long 0x04e20364
.long 0x05580062
.long 0x04de03dc
.long 0x04dc025c
.long 0x04da035c
.long 0x0550005a
.long 0x04d603d4
.long 0x04d40254
.long 0x04d20354
.long 0x05480052
.long 0x04ce03cc
.long 0x04cc024c
.long 0x04ca034c
.long 0x0540004a
.long 0x04c603c4
.long 0x04c40244
.long 0x04c20344
.long 0x05380042
.long 0x04be03bc
.long 0x04bc023c
.long 0x04ba033c
.long 0x0530003a
.long 0x04b603b4
.long 0x04b40234
.long 0x04b20334
.long 0x05280032
.long 0x04ae03ac
.long 0x04ac022c
.long 0x04aa032c
.long 0x0520002a
.long 0x04a603a4
.long 0x04a40224
.long 0x04a20324
.long 0x05180022
.long 0x049e039c
.long 0x049c021c
.long 0x049a031c
.long 0x0510001a
.long 0x04960394
.long 0x04940214
.long 0x04920314
.long 0x05080012
.long 0x048e038c
.long 0x048c020c
.long 0x048a030c
.long 0x0500000a
.long 0x04860384
.long 0x04840204
.long 0x04820304
.long 0x04f80002
.long 0x047e03fa
.long 0x047c027a
.long 0x047a037a
.long 0x04f00078
.long 0x047603f2
.long 0x04740272
.long 0x04720372
.long 0x04e80070
.long 0x046e03ea
.long 0x046c026a
.long 0x046a036a
.long 0x04e00068
.long 0x046603e2
.long 0x04640262
.long 0x04620362
.long 0x04d80060
.long 0x045e03da
.long 0x045c025a
.long 0x045a035a
.long 0x04d00058
.long 0x045603d2
.long 0x04540252
.long 0x04520352
.long 0x04c80050
.long 0x044e03ca
.long 0x044c024a
.long 0x044a034a
.long 0x04c00048
.long 0x044603c2
.long 0x04440242
.long 0x04420342
.long 0x04b80040
.long 0x043e03ba
.long 0x043c023a
.long 0x043a033a
.long 0x04b00038
.long 0x043603b2
.long 0x04340232
.long 0x04320332
.long 0x04a80030
.long 0x042e03aa
.long 0x042c022a
.long 0x042a032a
.long 0x04a00028
.long 0x042603a2
.long 0x04240222
.long 0x04220322
.long 0x04980020
.long 0x041e039a
.long 0x041c021a
.long 0x041a031a
.long 0x04900018
.long 0x04160392
.long 0x04140212
.long 0x04120312
.long 0x04880010
.long 0x040e038a
.long 0x040c020a
.long 0x040a030a
.long 0x04800008
.long 0x04060382
.long 0x04040202
.long 0x04020302
.long 0x06000000
.long 0x06000600
.long 0x06000600
.long 0x06000600
.long 0x06000600
.long 0x06000600
.long 0x06000600
.long 0x06000600
.long 0x06000600
.long 0x06000600
.long 0x06000600
.long 0x06000600
.long 0x06000600
.long 0x06000600
.long 0x06000600
.long 0x06000600
.long 0x06000600
.long 0x06000600
.long 0x06000600
.long 0x06000600
.long 0x06000600
.long 0x06000600
.long 0x06000600
.long 0x06000600
.long 0x06000600
.long 0x06000600
.long 0x06000600
.long 0x06000600
.long 0x06000600
.long 0x06000600
.long 0x06000600
.long 0x06000600
.long 0x06000600
.globl kC_kernel
.p2align 8
.type kC_kernel,@function
kC_kernel:
  s_cmp_ge_u32 s2, 256
  s_cbranch_scc1 E_end
  s_load_dwordx2 s[8:9], s[0:1], 88
  s_load_dwordx2 s[4:5], s[0:1], 104
  v_lshrrev_b32 v1, 6, v0
  v_and_b32 v0, 63, v0
  v_readfirstlane_b32 s12, v1
  s_and_b32 s13, s2, 6
  s_lshr_b32 s14, s2, 3
  s_and_b32 s15, s14, 3
  s_lshl_b32 s13, s13, 1
  s_add_u32 s13, s13, s15
  s_lshr_b32 s14, s14, 2
  s_and_b32 s15, s2, 1
  s_lshl_b32 s15, s15, 3
  s_add_u32 s14, s14, s15
  v_lshlrev_b32 v4, 4, v0
  v_and_b32 v2, 31, v0
  v_lshrrev_b32 v3, 5, v0
  v_lshlrev_b32 v5, 15, v3
  v_lshl_add_u32 v5, v2, 4, v5
  s_lshl_b32 s21, s13, 2
  s_add_u32 s21, s21, s12
  s_lshl_b32 s16, s21, 9
  s_add_u32 s16, s16, 4587520
  s_mul_i32 s17, s14, 251904
  s_add_u32 s17, s17, 7208960
  s_lshl_b32 s19, s12, 10
  s_add_u32 s18, s17, s19
  s_lshl_b32 s20, s12, 11
  v_add_u32 v1, s19, v4
  s_mov_b32 s38, 0
  s_lshl_b32 s39, s38, 19
  s_add_u32 s40, s16, s39
  s_lshl_b32 s39, s38, 13
  s_add_u32 s46, s18, s39
  s_mov_b32 s6, 23199744
  s_mov_b32 s7, 0x00020000
  s_waitcnt lgkmcnt(0)
  s_add_u32 m0, s19, 0
  s_add_u32 s24, s46, 0
  buffer_load_dwordx4 v4, s[4:7], s24 offen lds
  s_add_u32 m0, s19, 40960
  s_add_u32 s24, s46, 41984
  buffer_load_dwordx4 v4, s[4:7], s24 offen lds
  s_add_u32 m0, s19, 81920
  s_add_u32 s24, s46, 83968
  buffer_load_dwordx4 v4, s[4:7], s24 offen lds
  s_add_u32 s25, s40, 0
  buffer_load_dwordx4 v[96:99], v5, s[4:7], s25 offen
  s_add_u32 s25, s40, 65536
  buffer_load_dwordx4 v[100:103], v5, s[4:7], s25 offen
  s_add_u32 s25, s40, 131072
  buffer_load_dwordx4 v[104:107], v5, s[4:7], s25 offen
  s_add_u32 s25, s40, 196608
  buffer_load_dwordx4 v[108:111], v5, s[4:7], s25 offen
  s_add_u32 m0, s19, 4096
  s_add_u32 s24, s46, 4096
  buffer_load_dwordx4 v4, s[4:7], s24 offen lds
  s_add_u32 m0, s19, 45056
  s_add_u32 s24, s46, 46080
  buffer_load_dwordx4 v4, s[4:7], s24 offen lds
  s_add_u32 m0, s19, 86016
  s_add_u32 s24, s46, 88064
  buffer_load_dwordx4 v4, s[4:7], s24 offen lds
  s_add_u32 s25, s40, 262144
  buffer_load_dwordx4 v[112:115], v5, s[4:7], s25 offen
  s_add_u32 s25, s40, 327680
  buffer_load_dwordx4 v[116:119], v5, s[4:7], s25 offen
  s_add_u32 s25, s40, 393216
  buffer_load_dwordx4 v[120:123], v5, s[4:7], s25 offen
  s_add_u32 s25, s40, 458752
  buffer_load_dwordx4 v[124:127], v5, s[4:7], s25 offen
  s_add_u32 s38, s38, 1
  s_cmp_eq_u32 s38, 5
  s_cselect_b32 s38, 0, s38
  s_lshl_b32 s39, s38, 19
  s_add_u32 s41, s16, s39
  s_lshl_b32 s39, s38, 13
  s_add_u32 s47, s18, s39
  s_add_u32 s38, s38, 1
  s_cmp_eq_u32 s38, 5
  s_cselect_b32 s38, 0, s38
  s_lshl_b32 s39, s38, 19
  s_add_u32 s42, s16, s39
  s_lshl_b32 s39, s38, 13
  s_add_u32 s48, s18, s39
  s_add_u32 s38, s38, 1
  s_cmp_eq_u32 s38, 5
  s_cselect_b32 s38, 0, s38
  s_lshl_b32 s39, s38, 19
  s_add_u32 s43, s16, s39
  s_lshl_b32 s39, s38, 13
  s_add_u32 s49, s18, s39
  s_add_u32 s38, s38, 1
  s_cmp_eq_u32 s38, 5
  s_cselect_b32 s38, 0, s38
  s_lshl_b32 s39, s38, 19
  s_add_u32 s44, s16, s39
  s_lshl_b32 s39, s38, 13
  s_add_u32 s50, s18, s39
  s_lshr_b32 s53, s14, 3
  s_lshl_b32 s53, s53, 2
  s_and_b32 s54, s14, 3
  s_add_u32 s53, s53, s54
  s_bfe_u32 s54, s14, 0x10002
  s_lshl_b32 s55, s13, 1
  s_add_u32 s54, s54, s55
  s_mul_i32 s52, s53, 245760
  s_mul_i32 s55, s12, 61440
  s_add_u32 s52, s52, s55
  s_add_u32 s52, s52, 11239424
  s_lshl_b32 s55, s13, 1
  s_add_u32 s55, s55, 0
  s_and_b32 s55, s55, 3
  s_mul_i32 s74, s55, 6144
  s_mul_i32 s55, s55, 15360
  s_add_u32 s70, s52, s55
  s_lshl_b32 s55, s13, 1
  s_add_u32 s55, s55, 1
  s_and_b32 s55, s55, 3
  s_mul_i32 s75, s55, 6144
  s_mul_i32 s55, s55, 15360
  s_add_u32 s71, s52, s55
  s_lshl_b32 s55, s13, 1
  s_add_u32 s55, s55, 2
  s_and_b32 s55, s55, 3
  s_mul_i32 s76, s55, 6144
  s_mul_i32 s55, s55, 15360
  s_add_u32 s72, s52, s55
  s_lshl_b32 s55, s13, 1
  s_add_u32 s55, s55, 3
  s_and_b32 s55, s55, 3
  s_mul_i32 s77, s55, 6144
  s_mul_i32 s55, s55, 15360
  s_add_u32 s73, s52, s55
  s_lshl_b32 s64, s13, 9
  s_add_u32 s64, s64, 23166976
  s_lshr_b32 s65, s14, 2
  s_lshl_b32 s65, s65, 7
  s_and_b32 s66, s14, 3
  s_lshl_b32 s66, s66, 2
  s_add_u32 s65, s65, s66
  s_add_u32 s65, s65, s64
  s_lshl_b32 s66, s12, 7
  s_add_u32 s64, s64, s66
  s_mov_b32 s67, 0
  s_mov_b32 s69, s12
  s_mul_i32 s60, s54, 196608
  s_mul_i32 s61, s12, 24576
  s_add_u32 s60, s60, s61
  s_add_u32 s60, s60, 13205504
  s_add_u32 s61, s69, 0
  s_and_b32 s61, s61, 3
  s_lshr_b32 s62, s61, 1
  s_mul_i32 s62, s62, 98304
  s_and_b32 s63, s61, 1
  s_lshl_b32 s63, s63, 8
  s_add_u32 s62, s62, s63
  s_add_u32 s56, s60, s62
  s_mul_i32 s61, s61, 15360
  s_add_u32 s32, s61, 0
  s_add_u32 s61, s69, 1
  s_and_b32 s61, s61, 3
  s_lshr_b32 s62, s61, 1
  s_mul_i32 s62, s62, 98304
  s_and_b32 s63, s61, 1
  s_lshl_b32 s63, s63, 8
  s_add_u32 s62, s62, s63
  s_add_u32 s57, s60, s62
  s_mul_i32 s61, s61, 15360
  s_add_u32 s33, s61, 0
  s_add_u32 s61, s69, 2
  s_and_b32 s61, s61, 3
  s_lshr_b32 s62, s61, 1
  s_mul_i32 s62, s62, 98304
  s_and_b32 s63, s61, 1
  s_lshl_b32 s63, s63, 8
  s_add_u32 s62, s62, s63
  s_add_u32 s58, s60, s62
  s_mul_i32 s61, s61, 15360
  s_add_u32 s34, s61, 5120
  s_add_u32 s61, s69, 3
  s_and_b32 s61, s61, 3
  s_lshr_b32 s62, s61, 1
  s_mul_i32 s62, s62, 98304
  s_and_b32 s63, s61, 1
  s_lshl_b32 s63, s63, 8
  s_add_u32 s62, s62, s63
  s_add_u32 s59, s60, s62
  s_mul_i32 s61, s61, 15360
  s_add_u32 s35, s61, 10240
  s_lshl_b32 s60, s54, 2
  s_add_u32 s60, s60, s69
  s_mul_i32 s61, s53, 327680
  s_lshl_b32 s22, s60, 8
  s_add_u32 s61, s61, s22
  s_add_u32 s61, s61, 4587520
  s_and_b32 s28, s53, 1
  s_xor_b32 s29, s28, 1
  s_lshl_b32 s36, s28, 16
  s_lshl_b32 s31, s29, 18
  s_add_u32 s36, s36, s61
  s_add_u32 s31, s31, s61
  s_add_u32 s37, s36, 131072
  s_mul_i32 s62, s60, 20480
  s_mul_i32 s63, s53, 160
  s_add_u32 s62, s62, s63
  s_lshl_b32 s28, s28, 5
  s_lshl_b32 s29, s29, 7
  s_add_u32 s63, s62, s29
  s_add_u32 s62, s62, s28
  s_mov_b32 s10, 2621440
  s_mov_b32 s11, 0x00020000
  v_add_u32 v6, 61440, v4
  v_add_u32 v7, 122880, v4
  v_mov_b32 v72, 0
  v_mov_b32 v73, 0
  v_mov_b32 v74, 0
  v_mov_b32 v75, 0
  s_mov_b32 s30, 0x3f803f80
  s_waitcnt vmcnt(11)
  s_barrier
  ds_read_b128 a[24:27], v4 offset:0
  ds_read_b128 a[28:31], v4 offset:40960
  ds_read_b128 a[32:35], v6 offset:20480
  ds_read_b128 a[36:39], v4 offset:1024
  ds_read_b128 a[40:43], v4 offset:41984
  ds_read_b128 a[44:47], v6 offset:21504
  s_waitcnt vmcnt(10) lgkmcnt(5)
  v_mfma_f32_32x32x16_bf16 v[8:23], a[24:27], v[96:99], 0
  ds_read_b128 a[48:51], v4 offset:2048
  s_waitcnt lgkmcnt(5)
  v_mfma_f32_32x32x16_bf16 v[24:39], a[28:31], v[96:99], 0
  ds_read_b128 a[52:55], v4 offset:43008
  s_add_u32 m0, s19, 8192
  s_add_u32 s24, s47, 0
  buffer_load_dwordx4 v4, s[4:7], s24 offen lds
  s_waitcnt lgkmcnt(5)
  v_mfma_f32_32x32x16_bf16 v[40:55], a[32:35], v[96:99], 0
  ds_read_b128 a[56:59], v6 offset:22528
  s_waitcnt vmcnt(10) lgkmcnt(5)
  v_mfma_f32_32x32x16_bf16 v[8:23], a[36:39], v[100:103], v[8:23]
  ds_read_b128 a[60:63], v4 offset:3072
  s_add_u32 m0, s19, 49152
  s_add_u32 s24, s47, 41984
  buffer_load_dwordx4 v4, s[4:7], s24 offen lds
  s_waitcnt lgkmcnt(5)
  v_mfma_f32_32x32x16_bf16 v[24:39], a[40:43], v[100:103], v[24:39]
  ds_read_b128 a[64:67], v4 offset:44032
  s_waitcnt lgkmcnt(5)
  v_mfma_f32_32x32x16_bf16 v[40:55], a[44:47], v[100:103], v[40:55]
  ds_read_b128 a[68:71], v6 offset:23552
  s_add_u32 m0, s19, 90112
  s_add_u32 s24, s47, 83968
  buffer_load_dwordx4 v4, s[4:7], s24 offen lds
  s_waitcnt vmcnt(11) lgkmcnt(5)
  v_mfma_f32_32x32x16_bf16 v[8:23], a[48:51], v[104:107], v[8:23]
  s_waitcnt vmcnt(7)
  s_barrier
  ds_read_b128 a[24:27], v4 offset:4096
  s_waitcnt lgkmcnt(5)
  v_mfma_f32_32x32x16_bf16 v[24:39], a[52:55], v[104:107], v[24:39]
  ds_read_b128 a[28:31], v4 offset:45056
  s_add_u32 s25, s41, 0
  buffer_load_dwordx4 v[128:131], v5, s[4:7], s25 offen
  s_waitcnt lgkmcnt(5)
  v_mfma_f32_32x32x16_bf16 v[40:55], a[56:59], v[104:107], v[40:55]
  ds_read_b128 a[32:35], v6 offset:24576
  s_waitcnt lgkmcnt(5)
  v_mfma_f32_32x32x16_bf16 v[8:23], a[60:63], v[108:111], v[8:23]
  ds_read_b128 a[36:39], v4 offset:5120
  s_add_u32 s25, s41, 65536
  buffer_load_dwordx4 v[132:135], v5, s[4:7], s25 offen
  s_waitcnt lgkmcnt(5)
  v_mfma_f32_32x32x16_bf16 v[24:39], a[64:67], v[108:111], v[24:39]
  ds_read_b128 a[40:43], v4 offset:46080
  s_waitcnt lgkmcnt(5)
  v_mfma_f32_32x32x16_bf16 v[40:55], a[68:71], v[108:111], v[40:55]
  ds_read_b128 a[44:47], v6 offset:25600
  s_add_u32 s25, s41, 131072
  buffer_load_dwordx4 v[136:139], v5, s[4:7], s25 offen
  v_dot2c_f32_bf16 v72, s30, v96
  v_dot2c_f32_bf16 v73, v96, v96
  v_dot2c_f32_bf16 v74, s30, v97
  v_dot2c_f32_bf16 v75, v97, v97
  v_dot2c_f32_bf16 v72, s30, v98
  v_dot2c_f32_bf16 v73, v98, v98
  v_dot2c_f32_bf16 v74, s30, v99
  v_dot2c_f32_bf16 v75, v99, v99
  s_add_u32 s25, s41, 196608
  buffer_load_dwordx4 v[140:143], v5, s[4:7], s25 offen
  v_dot2c_f32_bf16 v72, s30, v100
  v_dot2c_f32_bf16 v73, v100, v100
  v_dot2c_f32_bf16 v74, s30, v101
  v_dot2c_f32_bf16 v75, v101, v101
  v_dot2c_f32_bf16 v72, s30, v102
  v_dot2c_f32_bf16 v73, v102, v102
  v_dot2c_f32_bf16 v74, s30, v103
  v_dot2c_f32_bf16 v75, v103, v103
  v_dot2c_f32_bf16 v72, s30, v104
  v_dot2c_f32_bf16 v73, v104, v104
  v_dot2c_f32_bf16 v74, s30, v105
  v_dot2c_f32_bf16 v75, v105, v105
  v_dot2c_f32_bf16 v72, s30, v106
  v_dot2c_f32_bf16 v73, v106, v106
  v_dot2c_f32_bf16 v74, s30, v107
  v_dot2c_f32_bf16 v75, v107, v107
  s_add_u32 s51, s70, 0
  buffer_load_dwordx4 a[72:75], v4, s[4:7], s51 offen offset:0
  v_dot2c_f32_bf16 v72, s30, v108
  v_dot2c_f32_bf16 v73, v108, v108
  v_dot2c_f32_bf16 v74, s30, v109
  v_dot2c_f32_bf16 v75, v109, v109
  v_dot2c_f32_bf16 v72, s30, v110
  v_dot2c_f32_bf16 v73, v110, v110
  v_dot2c_f32_bf16 v74, s30, v111
  v_dot2c_f32_bf16 v75, v111, v111
  s_waitcnt vmcnt(11) lgkmcnt(5)
  v_mfma_f32_32x32x16_bf16 v[8:23], a[24:27], v[112:115], v[8:23]
  ds_read_b128 a[48:51], v4 offset:6144
  s_waitcnt lgkmcnt(5)
  v_mfma_f32_32x32x16_bf16 v[24:39], a[28:31], v[112:115], v[24:39]
  ds_read_b128 a[52:55], v4 offset:47104
  s_add_u32 m0, s19, 12288
  s_add_u32 s24, s47, 4096
  buffer_load_dwordx4 v4, s[4:7], s24 offen lds
  s_waitcnt lgkmcnt(5)
  v_mfma_f32_32x32x16_bf16 v[40:55], a[32:35], v[112:115], v[40:55]
  ds_read_b128 a[56:59], v6 offset:26624
  s_waitcnt vmcnt(11) lgkmcnt(5)
  v_mfma_f32_32x32x16_bf16 v[8:23], a[36:39], v[116:119], v[8:23]
  ds_read_b128 a[60:63], v4 offset:7168
  s_add_u32 m0, s19, 53248
  s_add_u32 s24, s47, 46080
  buffer_load_dwordx4 v4, s[4:7], s24 offen lds
  s_waitcnt lgkmcnt(5)
  v_mfma_f32_32x32x16_bf16 v[24:39], a[40:43], v[116:119], v[24:39]
  ds_read_b128 a[64:67], v4 offset:48128
  s_waitcnt lgkmcnt(5)
  v_mfma_f32_32x32x16_bf16 v[40:55], a[44:47], v[116:119], v[40:55]
  ds_read_b128 a[68:71], v6 offset:27648
  s_add_u32 m0, s19, 94208
  s_add_u32 s24, s47, 88064
  buffer_load_dwordx4 v4, s[4:7], s24 offen lds
  s_waitcnt vmcnt(12) lgkmcnt(5)
  v_mfma_f32_32x32x16_bf16 v[8:23], a[48:51], v[120:123], v[8:23]
  s_waitcnt vmcnt(8)
  s_barrier
  ds_read_b128 a[24:27], v4 offset:8192
  s_waitcnt lgkmcnt(5)
  v_mfma_f32_32x32x16_bf16 v[24:39], a[52:55], v[120:123], v[24:39]
  ds_read_b128 a[28:31], v4 offset:49152
  s_add_u32 s25, s41, 262144
  buffer_load_dwordx4 v[144:147], v5, s[4:7], s25 offen
  s_waitcnt lgkmcnt(5)
  v_mfma_f32_32x32x16_bf16 v[40:55], a[56:59], v[120:123], v[40:55]
  ds_read_b128 a[32:35], v6 offset:28672
  s_waitcnt lgkmcnt(5)
  v_mfma_f32_32x32x16_bf16 v[8:23], a[60:63], v[124:127], v[8:23]
  ds_read_b128 a[36:39], v4 offset:9216
  s_add_u32 s25, s41, 327680
  buffer_load_dwordx4 v[148:151], v5, s[4:7], s25 offen
  s_waitcnt lgkmcnt(5)
  v_mfma_f32_32x32x16_bf16 v[24:39], a[64:67], v[124:127], v[24:39]
  ds_read_b128 a[40:43], v4 offset:50176
  s_waitcnt lgkmcnt(5)
  v_mfma_f32_32x32x16_bf16 v[40:55], a[68:71], v[124:127], v[40:55]
  ds_read_b128 a[44:47], v6 offset:29696
  s_add_u32 s25, s41, 393216
  buffer_load_dwordx4 v[152:155], v5, s[4:7], s25 offen
  v_dot2c_f32_bf16 v72, s30, v112
  v_dot2c_f32_bf16 v73, v112, v112
  v_dot2c_f32_bf16 v74, s30, v113
  v_dot2c_f32_bf16 v75, v113, v113
  v_dot2c_f32_bf16 v72, s30, v114
  v_dot2c_f32_bf16 v73, v114, v114
  v_dot2c_f32_bf16 v74, s30, v115
  v_dot2c_f32_bf16 v75, v115, v115
  s_add_u32 s25, s41, 458752
  buffer_load_dwordx4 v[156:159], v5, s[4:7], s25 offen
  v_dot2c_f32_bf16 v72, s30, v116
  v_dot2c_f32_bf16 v73, v116, v116
  v_dot2c_f32_bf16 v74, s30, v117
  v_dot2c_f32_bf16 v75, v117, v117
  v_dot2c_f32_bf16 v72, s30, v118
  v_dot2c_f32_bf16 v73, v118, v118
  v_dot2c_f32_bf16 v74, s30, v119
  v_dot2c_f32_bf16 v75, v119, v119
  v_dot2c_f32_bf16 v72, s30, v120
  v_dot2c_f32_bf16 v73, v120, v120
  v_dot2c_f32_bf16 v74, s30, v121
  v_dot2c_f32_bf16 v75, v121, v121
  v_dot2c_f32_bf16 v72, s30, v122
  v_dot2c_f32_bf16 v73, v122, v122
  v_dot2c_f32_bf16 v74, s30, v123
  v_dot2c_f32_bf16 v75, v123, v123
  buffer_load_dwordx4 a[76:79], v4, s[4:7], s51 offen offset:1024
  v_dot2c_f32_bf16 v72, s30, v124
  v_dot2c_f32_bf16 v73, v124, v124
  v_dot2c_f32_bf16 v74, s30, v125
  v_dot2c_f32_bf16 v75, v125, v125
  v_dot2c_f32_bf16 v72, s30, v126
  v_dot2c_f32_bf16 v73, v126, v126
  v_dot2c_f32_bf16 v74, s30, v127
  v_dot2c_f32_bf16 v75, v127, v127
  s_waitcnt vmcnt(12) lgkmcnt(5)
  v_mfma_f32_32x32x16_bf16 v[8:23], a[24:27], v[128:131], v[8:23]
  ds_read_b128 a[48:51], v4 offset:10240
  s_waitcnt lgkmcnt(5)
  v_mfma_f32_32x32x16_bf16 v[24:39], a[28:31], v[128:131], v[24:39]
  ds_read_b128 a[52:55], v4 offset:51200
  s_add_u32 m0, s19, 16384
  s_add_u32 s24, s48, 0
  buffer_load_dwordx4 v4, s[4:7], s24 offen lds
  s_waitcnt lgkmcnt(5)
  v_mfma_f32_32x32x16_bf16 v[40:55], a[32:35], v[128:131], v[40:55]
  ds_read_b128 a[56:59], v6 offset:30720
  s_waitcnt vmcnt(12) lgkmcnt(5)
  v_mfma_f32_32x32x16_bf16 v[8:23], a[36:39], v[132:135], v[8:23]
  ds_read_b128 a[60:63], v4 offset:11264
  s_add_u32 m0, s19, 57344
  s_add_u32 s24, s48, 41984
  buffer_load_dwordx4 v4, s[4:7], s24 offen lds
  s_waitcnt lgkmcnt(5)
  v_mfma_f32_32x32x16_bf16 v[24:39], a[40:43], v[132:135], v[24:39]
  ds_read_b128 a[64:67], v4 offset:52224
  s_waitcnt lgkmcnt(5)
  v_mfma_f32_32x32x16_bf16 v[40:55], a[44:47], v[132:135], v[40:55]
  ds_read_b128 a[68:71], v6 offset:31744
  s_add_u32 m0, s19, 98304
  s_add_u32 s24, s48, 83968
  buffer_load_dwordx4 v4, s[4:7], s24 offen lds
  s_waitcnt vmcnt(13) lgkmcnt(5)
  v_mfma_f32_32x32x16_bf16 v[8:23], a[48:51], v[136:139], v[8:23]
  s_waitcnt vmcnt(8)
  s_barrier
  ds_read_b128 a[24:27], v4 offset:12288
  s_waitcnt lgkmcnt(5)
  v_mfma_f32_32x32x16_bf16 v[24:39], a[52:55], v[136:139], v[24:39]
  ds_read_b128 a[28:31], v4 offset:53248
  s_add_u32 s25, s42, 0
  buffer_load_dwordx4 v[160:163], v5, s[4:7], s25 offen
  s_waitcnt lgkmcnt(5)
  v_mfma_f32_32x32x16_bf16 v[40:55], a[56:59], v[136:139], v[40:55]
  ds_read_b128 a[32:35], v6 offset:32768
  s_waitcnt lgkmcnt(5)
  v_mfma_f32_32x32x16_bf16 v[8:23], a[60:63], v[140:143], v[8:23]
  ds_read_b128 a[36:39], v4 offset:13312
  s_add_u32 s25, s42, 65536
  buffer_load_dwordx4 v[164:167], v5, s[4:7], s25 offen
  s_waitcnt lgkmcnt(5)
  v_mfma_f32_32x32x16_bf16 v[24:39], a[64:67], v[140:143], v[24:39]
  ds_read_b128 a[40:43], v4 offset:54272
  s_waitcnt lgkmcnt(5)
  v_mfma_f32_32x32x16_bf16 v[40:55], a[68:71], v[140:143], v[40:55]
  ds_read_b128 a[44:47], v6 offset:33792
  s_add_u32 s25, s42, 131072
  buffer_load_dwordx4 v[168:171], v5, s[4:7], s25 offen
  v_dot2c_f32_bf16 v72, s30, v128
  v_dot2c_f32_bf16 v73, v128, v128
  v_dot2c_f32_bf16 v74, s30, v129
  v_dot2c_f32_bf16 v75, v129, v129
  v_dot2c_f32_bf16 v72, s30, v130
  v_dot2c_f32_bf16 v73, v130, v130
  v_dot2c_f32_bf16 v74, s30, v131
  v_dot2c_f32_bf16 v75, v131, v131
  s_add_u32 s25, s42, 196608
  buffer_load_dwordx4 v[172:175], v5, s[4:7], s25 offen
  v_dot2c_f32_bf16 v72, s30, v132
  v_dot2c_f32_bf16 v73, v132, v132
  v_dot2c_f32_bf16 v74, s30, v133
  v_dot2c_f32_bf16 v75, v133, v133
  v_dot2c_f32_bf16 v72, s30, v134
  v_dot2c_f32_bf16 v73, v134, v134
  v_dot2c_f32_bf16 v74, s30, v135
  v_dot2c_f32_bf16 v75, v135, v135
  v_dot2c_f32_bf16 v72, s30, v136
  v_dot2c_f32_bf16 v73, v136, v136
  v_dot2c_f32_bf16 v74, s30, v137
  v_dot2c_f32_bf16 v75, v137, v137
  v_dot2c_f32_bf16 v72, s30, v138
  v_dot2c_f32_bf16 v73, v138, v138
  v_dot2c_f32_bf16 v74, s30, v139
  v_dot2c_f32_bf16 v75, v139, v139
  buffer_load_dwordx4 a[80:83], v4, s[4:7], s51 offen offset:2048
  v_dot2c_f32_bf16 v72, s30, v140
  v_dot2c_f32_bf16 v73, v140, v140
  v_dot2c_f32_bf16 v74, s30, v141
  v_dot2c_f32_bf16 v75, v141, v141
  v_dot2c_f32_bf16 v72, s30, v142
  v_dot2c_f32_bf16 v73, v142, v142
  v_dot2c_f32_bf16 v74, s30, v143
  v_dot2c_f32_bf16 v75, v143, v143
  s_waitcnt vmcnt(12) lgkmcnt(5)
  v_mfma_f32_32x32x16_bf16 v[8:23], a[24:27], v[144:147], v[8:23]
  ds_read_b128 a[48:51], v4 offset:14336
  s_waitcnt lgkmcnt(5)
  v_mfma_f32_32x32x16_bf16 v[24:39], a[28:31], v[144:147], v[24:39]
  ds_read_b128 a[52:55], v4 offset:55296
  s_add_u32 m0, s19, 20480
  s_add_u32 s24, s48, 4096
  buffer_load_dwordx4 v4, s[4:7], s24 offen lds
  s_waitcnt lgkmcnt(5)
  v_mfma_f32_32x32x16_bf16 v[40:55], a[32:35], v[144:147], v[40:55]
  ds_read_b128 a[56:59], v6 offset:34816
  s_waitcnt vmcnt(12) lgkmcnt(5)
  v_mfma_f32_32x32x16_bf16 v[8:23], a[36:39], v[148:151], v[8:23]
  ds_read_b128 a[60:63], v4 offset:15360
  s_add_u32 m0, s19, 61440
  s_add_u32 s24, s48, 46080
  buffer_load_dwordx4 v4, s[4:7], s24 offen lds
  s_waitcnt lgkmcnt(5)
  v_mfma_f32_32x32x16_bf16 v[24:39], a[40:43], v[148:151], v[24:39]
  ds_read_b128 a[64:67], v4 offset:56320
  s_waitcnt lgkmcnt(5)
  v_mfma_f32_32x32x16_bf16 v[40:55], a[44:47], v[148:151], v[40:55]
  ds_read_b128 a[68:71], v6 offset:35840
  s_add_u32 m0, s19, 102400
  s_add_u32 s24, s48, 88064
  buffer_load_dwordx4 v4, s[4:7], s24 offen lds
  s_waitcnt vmcnt(13) lgkmcnt(5)
  v_mfma_f32_32x32x16_bf16 v[8:23], a[48:51], v[152:155], v[8:23]
  s_waitcnt vmcnt(8)
  s_barrier
  ds_read_b128 a[24:27], v4 offset:16384
  s_waitcnt lgkmcnt(5)
  v_mfma_f32_32x32x16_bf16 v[24:39], a[52:55], v[152:155], v[24:39]
  ds_read_b128 a[28:31], v4 offset:57344
  s_add_u32 s25, s42, 262144
  buffer_load_dwordx4 v[176:179], v5, s[4:7], s25 offen
  s_waitcnt lgkmcnt(5)
  v_mfma_f32_32x32x16_bf16 v[40:55], a[56:59], v[152:155], v[40:55]
  ds_read_b128 a[32:35], v6 offset:36864
  s_waitcnt lgkmcnt(5)
  v_mfma_f32_32x32x16_bf16 v[8:23], a[60:63], v[156:159], v[8:23]
  ds_read_b128 a[36:39], v4 offset:17408
  s_add_u32 s25, s42, 327680
  buffer_load_dwordx4 v[180:183], v5, s[4:7], s25 offen
  s_waitcnt lgkmcnt(5)
  v_mfma_f32_32x32x16_bf16 v[24:39], a[64:67], v[156:159], v[24:39]
  ds_read_b128 a[40:43], v4 offset:58368
  s_waitcnt lgkmcnt(5)
  v_mfma_f32_32x32x16_bf16 v[40:55], a[68:71], v[156:159], v[40:55]
  ds_read_b128 a[44:47], v6 offset:37888
  s_add_u32 s25, s42, 393216
  buffer_load_dwordx4 v[184:187], v5, s[4:7], s25 offen
  v_dot2c_f32_bf16 v72, s30, v144
  v_dot2c_f32_bf16 v73, v144, v144
  v_dot2c_f32_bf16 v74, s30, v145
  v_dot2c_f32_bf16 v75, v145, v145
  v_dot2c_f32_bf16 v72, s30, v146
  v_dot2c_f32_bf16 v73, v146, v146
  v_dot2c_f32_bf16 v74, s30, v147
  v_dot2c_f32_bf16 v75, v147, v147
  s_add_u32 s25, s42, 458752
  buffer_load_dwordx4 v[188:191], v5, s[4:7], s25 offen
  v_dot2c_f32_bf16 v72, s30, v148
  v_dot2c_f32_bf16 v73, v148, v148
  v_dot2c_f32_bf16 v74, s30, v149
  v_dot2c_f32_bf16 v75, v149, v149
  v_dot2c_f32_bf16 v72, s30, v150
  v_dot2c_f32_bf16 v73, v150, v150
  v_dot2c_f32_bf16 v74, s30, v151
  v_dot2c_f32_bf16 v75, v151, v151
  v_dot2c_f32_bf16 v72, s30, v152
  v_dot2c_f32_bf16 v73, v152, v152
  v_dot2c_f32_bf16 v74, s30, v153
  v_dot2c_f32_bf16 v75, v153, v153
  v_dot2c_f32_bf16 v72, s30, v154
  v_dot2c_f32_bf16 v73, v154, v154
  v_dot2c_f32_bf16 v74, s30, v155
  v_dot2c_f32_bf16 v75, v155, v155
  buffer_load_dwordx4 a[84:87], v4, s[4:7], s51 offen offset:3072
  v_dot2c_f32_bf16 v72, s30, v156
  v_dot2c_f32_bf16 v73, v156, v156
  v_dot2c_f32_bf16 v74, s30, v157
  v_dot2c_f32_bf16 v75, v157, v157
  v_dot2c_f32_bf16 v72, s30, v158
  v_dot2c_f32_bf16 v73, v158, v158
  v_dot2c_f32_bf16 v74, s30, v159
  v_dot2c_f32_bf16 v75, v159, v159
  s_waitcnt vmcnt(12) lgkmcnt(5)
  v_mfma_f32_32x32x16_bf16 v[8:23], a[24:27], v[160:163], v[8:23]
  ds_read_b128 a[48:51], v4 offset:18432
  s_waitcnt lgkmcnt(5)
  v_mfma_f32_32x32x16_bf16 v[24:39], a[28:31], v[160:163], v[24:39]
  ds_read_b128 a[52:55], v4 offset:59392
  s_add_u32 m0, s19, 24576
  s_add_u32 s24, s49, 0
  buffer_load_dwordx4 v4, s[4:7], s24 offen lds
  s_waitcnt lgkmcnt(5)
  v_mfma_f32_32x32x16_bf16 v[40:55], a[32:35], v[160:163], v[40:55]
  ds_read_b128 a[56:59], v6 offset:38912
  s_waitcnt vmcnt(12) lgkmcnt(5)
  v_mfma_f32_32x32x16_bf16 v[8:23], a[36:39], v[164:167], v[8:23]
  ds_read_b128 a[60:63], v4 offset:19456
  s_add_u32 m0, s19, 65536
  s_add_u32 s24, s49, 41984
  buffer_load_dwordx4 v4, s[4:7], s24 offen lds
  s_waitcnt lgkmcnt(5)
  v_mfma_f32_32x32x16_bf16 v[24:39], a[40:43], v[164:167], v[24:39]
  ds_read_b128 a[64:67], v4 offset:60416
  s_waitcnt lgkmcnt(5)
  v_mfma_f32_32x32x16_bf16 v[40:55], a[44:47], v[164:167], v[40:55]
  ds_read_b128 a[68:71], v6 offset:39936
  s_add_u32 m0, s19, 106496
  s_add_u32 s24, s49, 83968
  buffer_load_dwordx4 v4, s[4:7], s24 offen lds
  s_waitcnt vmcnt(13) lgkmcnt(5)
  v_mfma_f32_32x32x16_bf16 v[8:23], a[48:51], v[168:171], v[8:23]
  s_waitcnt vmcnt(8)
  s_barrier
  ds_read_b128 a[24:27], v4 offset:20480
  s_waitcnt lgkmcnt(5)
  v_mfma_f32_32x32x16_bf16 v[24:39], a[52:55], v[168:171], v[24:39]
  ds_read_b128 a[28:31], v6 offset:0
  s_add_u32 s25, s43, 0
  buffer_load_dwordx4 v[192:195], v5, s[4:7], s25 offen
  s_waitcnt lgkmcnt(5)
  v_mfma_f32_32x32x16_bf16 v[40:55], a[56:59], v[168:171], v[40:55]
  ds_read_b128 a[32:35], v6 offset:40960
  s_waitcnt lgkmcnt(5)
  v_mfma_f32_32x32x16_bf16 v[8:23], a[60:63], v[172:175], v[8:23]
  ds_read_b128 a[36:39], v4 offset:21504
  s_add_u32 s25, s43, 65536
  buffer_load_dwordx4 v[196:199], v5, s[4:7], s25 offen
  s_waitcnt lgkmcnt(5)
  v_mfma_f32_32x32x16_bf16 v[24:39], a[64:67], v[172:175], v[24:39]
  ds_read_b128 a[40:43], v6 offset:1024
  s_waitcnt lgkmcnt(5)
  v_mfma_f32_32x32x16_bf16 v[40:55], a[68:71], v[172:175], v[40:55]
  ds_read_b128 a[44:47], v6 offset:41984
  s_add_u32 s25, s43, 131072
  buffer_load_dwordx4 v[200:203], v5, s[4:7], s25 offen
  v_dot2c_f32_bf16 v72, s30, v160
  v_dot2c_f32_bf16 v73, v160, v160
  v_dot2c_f32_bf16 v74, s30, v161
  v_dot2c_f32_bf16 v75, v161, v161
  v_dot2c_f32_bf16 v72, s30, v162
  v_dot2c_f32_bf16 v73, v162, v162
  v_dot2c_f32_bf16 v74, s30, v163
  v_dot2c_f32_bf16 v75, v163, v163
  s_add_u32 s25, s43, 196608
  buffer_load_dwordx4 v[204:207], v5, s[4:7], s25 offen
  v_dot2c_f32_bf16 v72, s30, v164
  v_dot2c_f32_bf16 v73, v164, v164
  v_dot2c_f32_bf16 v74, s30, v165
  v_dot2c_f32_bf16 v75, v165, v165
  v_dot2c_f32_bf16 v72, s30, v166
  v_dot2c_f32_bf16 v73, v166, v166
  v_dot2c_f32_bf16 v74, s30, v167
  v_dot2c_f32_bf16 v75, v167, v167
  v_dot2c_f32_bf16 v72, s30, v168
  v_dot2c_f32_bf16 v73, v168, v168
  v_dot2c_f32_bf16 v74, s30, v169
  v_dot2c_f32_bf16 v75, v169, v169
  v_dot2c_f32_bf16 v72, s30, v170
  v_dot2c_f32_bf16 v73, v170, v170
  v_dot2c_f32_bf16 v74, s30, v171
  v_dot2c_f32_bf16 v75, v171, v171
  s_add_u32 s51, s70, 4096
  buffer_load_dwordx4 a[88:91], v4, s[4:7], s51 offen offset:0
  v_dot2c_f32_bf16 v72, s30, v172
  v_dot2c_f32_bf16 v73, v172, v172
  v_dot2c_f32_bf16 v74, s30, v173
  v_dot2c_f32_bf16 v75, v173, v173
  v_dot2c_f32_bf16 v72, s30, v174
  v_dot2c_f32_bf16 v73, v174, v174
  v_dot2c_f32_bf16 v74, s30, v175
  v_dot2c_f32_bf16 v75, v175, v175
  s_waitcnt vmcnt(12) lgkmcnt(5)
  v_mfma_f32_32x32x16_bf16 v[8:23], a[24:27], v[176:179], v[8:23]
  ds_read_b128 a[48:51], v4 offset:22528
  s_waitcnt lgkmcnt(5)
  v_mfma_f32_32x32x16_bf16 v[24:39], a[28:31], v[176:179], v[24:39]
  ds_read_b128 a[52:55], v6 offset:2048
  s_add_u32 m0, s19, 28672
  s_add_u32 s24, s49, 4096
  buffer_load_dwordx4 v4, s[4:7], s24 offen lds
  s_waitcnt lgkmcnt(5)
  v_mfma_f32_32x32x16_bf16 v[40:55], a[32:35], v[176:179], v[40:55]
  ds_read_b128 a[56:59], v6 offset:43008
  s_waitcnt vmcnt(12) lgkmcnt(5)
  v_mfma_f32_32x32x16_bf16 v[8:23], a[36:39], v[180:183], v[8:23]
  ds_read_b128 a[60:63], v4 offset:23552
  s_add_u32 m0, s19, 69632
  s_add_u32 s24, s49, 46080
  buffer_load_dwordx4 v4, s[4:7], s24 offen lds
  s_waitcnt lgkmcnt(5)
  v_mfma_f32_32x32x16_bf16 v[24:39], a[40:43], v[180:183], v[24:39]
  ds_read_b128 a[64:67], v6 offset:3072
  s_waitcnt lgkmcnt(5)
  v_mfma_f32_32x32x16_bf16 v[40:55], a[44:47], v[180:183], v[40:55]
  ds_read_b128 a[68:71], v6 offset:44032
  s_add_u32 m0, s19, 110592
  s_add_u32 s24, s49, 88064
  buffer_load_dwordx4 v4, s[4:7], s24 offen lds
  s_waitcnt vmcnt(13) lgkmcnt(5)
  v_mfma_f32_32x32x16_bf16 v[8:23], a[48:51], v[184:187], v[8:23]
  s_waitcnt vmcnt(8)
  s_barrier
  ds_read_b128 a[24:27], v4 offset:24576
  s_waitcnt lgkmcnt(5)
  v_mfma_f32_32x32x16_bf16 v[24:39], a[52:55], v[184:187], v[24:39]
  ds_read_b128 a[28:31], v6 offset:4096
  s_add_u32 s25, s43, 262144
  buffer_load_dwordx4 v[208:211], v5, s[4:7], s25 offen
  s_waitcnt lgkmcnt(5)
  v_mfma_f32_32x32x16_bf16 v[40:55], a[56:59], v[184:187], v[40:55]
  ds_read_b128 a[32:35], v6 offset:45056
  s_waitcnt lgkmcnt(5)
  v_mfma_f32_32x32x16_bf16 v[8:23], a[60:63], v[188:191], v[8:23]
  ds_read_b128 a[36:39], v4 offset:25600
  s_add_u32 s25, s43, 327680
  buffer_load_dwordx4 v[212:215], v5, s[4:7], s25 offen
  s_waitcnt lgkmcnt(5)
  v_mfma_f32_32x32x16_bf16 v[24:39], a[64:67], v[188:191], v[24:39]
  ds_read_b128 a[40:43], v6 offset:5120
  s_waitcnt lgkmcnt(5)
  v_mfma_f32_32x32x16_bf16 v[40:55], a[68:71], v[188:191], v[40:55]
  ds_read_b128 a[44:47], v6 offset:46080
  s_add_u32 s25, s43, 393216
  buffer_load_dwordx4 v[216:219], v5, s[4:7], s25 offen
  v_dot2c_f32_bf16 v72, s30, v176
  v_dot2c_f32_bf16 v73, v176, v176
  v_dot2c_f32_bf16 v74, s30, v177
  v_dot2c_f32_bf16 v75, v177, v177
  v_dot2c_f32_bf16 v72, s30, v178
  v_dot2c_f32_bf16 v73, v178, v178
  v_dot2c_f32_bf16 v74, s30, v179
  v_dot2c_f32_bf16 v75, v179, v179
  s_add_u32 s25, s43, 458752
  buffer_load_dwordx4 v[220:223], v5, s[4:7], s25 offen
  v_dot2c_f32_bf16 v72, s30, v180
  v_dot2c_f32_bf16 v73, v180, v180
  v_dot2c_f32_bf16 v74, s30, v181
  v_dot2c_f32_bf16 v75, v181, v181
  v_dot2c_f32_bf16 v72, s30, v182
  v_dot2c_f32_bf16 v73, v182, v182
  v_dot2c_f32_bf16 v74, s30, v183
  v_dot2c_f32_bf16 v75, v183, v183
  v_dot2c_f32_bf16 v72, s30, v184
  v_dot2c_f32_bf16 v73, v184, v184
  v_dot2c_f32_bf16 v74, s30, v185
  v_dot2c_f32_bf16 v75, v185, v185
  v_dot2c_f32_bf16 v72, s30, v186
  v_dot2c_f32_bf16 v73, v186, v186
  v_dot2c_f32_bf16 v74, s30, v187
  v_dot2c_f32_bf16 v75, v187, v187
  buffer_load_dwordx4 a[92:95], v4, s[4:7], s51 offen offset:1024
  v_dot2c_f32_bf16 v72, s30, v188
  v_dot2c_f32_bf16 v73, v188, v188
  v_dot2c_f32_bf16 v74, s30, v189
  v_dot2c_f32_bf16 v75, v189, v189
  v_dot2c_f32_bf16 v72, s30, v190
  v_dot2c_f32_bf16 v73, v190, v190
  v_dot2c_f32_bf16 v74, s30, v191
  v_dot2c_f32_bf16 v75, v191, v191
  s_waitcnt vmcnt(12) lgkmcnt(5)
  v_mfma_f32_32x32x16_bf16 v[8:23], a[24:27], v[192:195], v[8:23]
  ds_read_b128 a[48:51], v4 offset:26624
  s_waitcnt lgkmcnt(5)
  v_mfma_f32_32x32x16_bf16 v[24:39], a[28:31], v[192:195], v[24:39]
  ds_read_b128 a[52:55], v6 offset:6144
  s_add_u32 m0, s19, 32768
  s_add_u32 s24, s50, 0
  buffer_load_dwordx4 v4, s[4:7], s24 offen lds
  s_waitcnt lgkmcnt(5)
  v_mfma_f32_32x32x16_bf16 v[40:55], a[32:35], v[192:195], v[40:55]
  ds_read_b128 a[56:59], v6 offset:47104
  s_waitcnt vmcnt(12) lgkmcnt(5)
  v_mfma_f32_32x32x16_bf16 v[8:23], a[36:39], v[196:199], v[8:23]
  ds_read_b128 a[60:63], v4 offset:27648
  s_add_u32 m0, s19, 73728
  s_add_u32 s24, s50, 41984
  buffer_load_dwordx4 v4, s[4:7], s24 offen lds
  s_waitcnt lgkmcnt(5)
  v_mfma_f32_32x32x16_bf16 v[24:39], a[40:43], v[196:199], v[24:39]
  ds_read_b128 a[64:67], v6 offset:7168
  s_waitcnt lgkmcnt(5)
  v_mfma_f32_32x32x16_bf16 v[40:55], a[44:47], v[196:199], v[40:55]
  ds_read_b128 a[68:71], v6 offset:48128
  s_add_u32 m0, s19, 114688
  s_add_u32 s24, s50, 83968
  buffer_load_dwordx4 v4, s[4:7], s24 offen lds
  s_waitcnt vmcnt(13) lgkmcnt(5)
  v_mfma_f32_32x32x16_bf16 v[8:23], a[48:51], v[200:203], v[8:23]
  s_waitcnt vmcnt(8)
  s_barrier
  ds_read_b128 a[24:27], v4 offset:28672
  s_waitcnt lgkmcnt(5)
  v_mfma_f32_32x32x16_bf16 v[24:39], a[52:55], v[200:203], v[24:39]
  ds_read_b128 a[28:31], v6 offset:8192
  s_add_u32 s25, s44, 0
  buffer_load_dwordx4 v[224:227], v5, s[4:7], s25 offen
  s_waitcnt lgkmcnt(5)
  v_mfma_f32_32x32x16_bf16 v[40:55], a[56:59], v[200:203], v[40:55]
  ds_read_b128 a[32:35], v6 offset:49152
  s_waitcnt lgkmcnt(5)
  v_mfma_f32_32x32x16_bf16 v[8:23], a[60:63], v[204:207], v[8:23]
  ds_read_b128 a[36:39], v4 offset:29696
  s_add_u32 s25, s44, 65536
  buffer_load_dwordx4 v[228:231], v5, s[4:7], s25 offen
  s_waitcnt lgkmcnt(5)
  v_mfma_f32_32x32x16_bf16 v[24:39], a[64:67], v[204:207], v[24:39]
  ds_read_b128 a[40:43], v6 offset:9216
  s_waitcnt lgkmcnt(5)
  v_mfma_f32_32x32x16_bf16 v[40:55], a[68:71], v[204:207], v[40:55]
  ds_read_b128 a[44:47], v6 offset:50176
  s_add_u32 s25, s44, 131072
  buffer_load_dwordx4 v[232:235], v5, s[4:7], s25 offen
  v_dot2c_f32_bf16 v72, s30, v192
  v_dot2c_f32_bf16 v73, v192, v192
  v_dot2c_f32_bf16 v74, s30, v193
  v_dot2c_f32_bf16 v75, v193, v193
  v_dot2c_f32_bf16 v72, s30, v194
  v_dot2c_f32_bf16 v73, v194, v194
  v_dot2c_f32_bf16 v74, s30, v195
  v_dot2c_f32_bf16 v75, v195, v195
  s_add_u32 s25, s44, 196608
  buffer_load_dwordx4 v[236:239], v5, s[4:7], s25 offen
  v_dot2c_f32_bf16 v72, s30, v196
  v_dot2c_f32_bf16 v73, v196, v196
  v_dot2c_f32_bf16 v74, s30, v197
  v_dot2c_f32_bf16 v75, v197, v197
  v_dot2c_f32_bf16 v72, s30, v198
  v_dot2c_f32_bf16 v73, v198, v198
  v_dot2c_f32_bf16 v74, s30, v199
  v_dot2c_f32_bf16 v75, v199, v199
  v_dot2c_f32_bf16 v72, s30, v200
  v_dot2c_f32_bf16 v73, v200, v200
  v_dot2c_f32_bf16 v74, s30, v201
  v_dot2c_f32_bf16 v75, v201, v201
  v_dot2c_f32_bf16 v72, s30, v202
  v_dot2c_f32_bf16 v73, v202, v202
  v_dot2c_f32_bf16 v74, s30, v203
  v_dot2c_f32_bf16 v75, v203, v203
  buffer_load_dwordx4 a[96:99], v4, s[4:7], s51 offen offset:2048
  v_dot2c_f32_bf16 v72, s30, v204
  v_dot2c_f32_bf16 v73, v204, v204
  v_dot2c_f32_bf16 v74, s30, v205
  v_dot2c_f32_bf16 v75, v205, v205
  v_dot2c_f32_bf16 v72, s30, v206
  v_dot2c_f32_bf16 v73, v206, v206
  v_dot2c_f32_bf16 v74, s30, v207
  v_dot2c_f32_bf16 v75, v207, v207
  s_waitcnt vmcnt(12) lgkmcnt(5)
  v_mfma_f32_32x32x16_bf16 v[8:23], a[24:27], v[208:211], v[8:23]
  ds_read_b128 a[48:51], v4 offset:30720
  s_waitcnt lgkmcnt(5)
  v_mfma_f32_32x32x16_bf16 v[24:39], a[28:31], v[208:211], v[24:39]
  ds_read_b128 a[52:55], v6 offset:10240
  s_add_u32 m0, s19, 36864
  s_add_u32 s24, s50, 4096
  buffer_load_dwordx4 v4, s[4:7], s24 offen lds
  s_waitcnt lgkmcnt(5)
  v_mfma_f32_32x32x16_bf16 v[40:55], a[32:35], v[208:211], v[40:55]
  ds_read_b128 a[56:59], v6 offset:51200
  s_waitcnt vmcnt(12) lgkmcnt(5)
  v_mfma_f32_32x32x16_bf16 v[8:23], a[36:39], v[212:215], v[8:23]
  ds_read_b128 a[60:63], v4 offset:31744
  s_add_u32 m0, s19, 77824
  s_add_u32 s24, s50, 46080
  buffer_load_dwordx4 v4, s[4:7], s24 offen lds
  s_waitcnt lgkmcnt(5)
  v_mfma_f32_32x32x16_bf16 v[24:39], a[40:43], v[212:215], v[24:39]
  ds_read_b128 a[64:67], v6 offset:11264
  s_waitcnt lgkmcnt(5)
  v_mfma_f32_32x32x16_bf16 v[40:55], a[44:47], v[212:215], v[40:55]
  ds_read_b128 a[68:71], v6 offset:52224
  s_add_u32 m0, s19, 118784
  s_add_u32 s24, s50, 88064
  buffer_load_dwordx4 v4, s[4:7], s24 offen lds
  s_waitcnt vmcnt(13) lgkmcnt(5)
  v_mfma_f32_32x32x16_bf16 v[8:23], a[48:51], v[216:219], v[8:23]
  s_waitcnt vmcnt(8)
  s_barrier
  ds_read_b128 a[24:27], v4 offset:32768
  s_waitcnt lgkmcnt(5)
  v_mfma_f32_32x32x16_bf16 v[24:39], a[52:55], v[216:219], v[24:39]
  ds_read_b128 a[28:31], v6 offset:12288
  s_add_u32 s25, s44, 262144
  buffer_load_dwordx4 v[240:243], v5, s[4:7], s25 offen
  s_waitcnt lgkmcnt(5)
  v_mfma_f32_32x32x16_bf16 v[40:55], a[56:59], v[216:219], v[40:55]
  ds_read_b128 a[32:35], v6 offset:53248
  s_waitcnt lgkmcnt(5)
  v_mfma_f32_32x32x16_bf16 v[8:23], a[60:63], v[220:223], v[8:23]
  ds_read_b128 a[36:39], v4 offset:33792
  s_add_u32 s25, s44, 327680
  buffer_load_dwordx4 v[244:247], v5, s[4:7], s25 offen
  s_waitcnt lgkmcnt(5)
  v_mfma_f32_32x32x16_bf16 v[24:39], a[64:67], v[220:223], v[24:39]
  ds_read_b128 a[40:43], v6 offset:13312
  s_waitcnt lgkmcnt(5)
  v_mfma_f32_32x32x16_bf16 v[40:55], a[68:71], v[220:223], v[40:55]
  ds_read_b128 a[44:47], v6 offset:54272
  s_add_u32 s25, s44, 393216
  buffer_load_dwordx4 v[248:251], v5, s[4:7], s25 offen
  v_dot2c_f32_bf16 v72, s30, v208
  v_dot2c_f32_bf16 v73, v208, v208
  v_dot2c_f32_bf16 v74, s30, v209
  v_dot2c_f32_bf16 v75, v209, v209
  v_dot2c_f32_bf16 v72, s30, v210
  v_dot2c_f32_bf16 v73, v210, v210
  v_dot2c_f32_bf16 v74, s30, v211
  v_dot2c_f32_bf16 v75, v211, v211
  s_add_u32 s25, s44, 458752
  buffer_load_dwordx4 v[252:255], v5, s[4:7], s25 offen
  v_dot2c_f32_bf16 v72, s30, v212
  v_dot2c_f32_bf16 v73, v212, v212
  v_dot2c_f32_bf16 v74, s30, v213
  v_dot2c_f32_bf16 v75, v213, v213
  v_dot2c_f32_bf16 v72, s30, v214
  v_dot2c_f32_bf16 v73, v214, v214
  v_dot2c_f32_bf16 v74, s30, v215
  v_dot2c_f32_bf16 v75, v215, v215
  v_dot2c_f32_bf16 v72, s30, v216
  v_dot2c_f32_bf16 v73, v216, v216
  v_dot2c_f32_bf16 v74, s30, v217
  v_dot2c_f32_bf16 v75, v217, v217
  v_dot2c_f32_bf16 v72, s30, v218
  v_dot2c_f32_bf16 v73, v218, v218
  v_dot2c_f32_bf16 v74, s30, v219
  v_dot2c_f32_bf16 v75, v219, v219
  buffer_load_dwordx4 a[100:103], v4, s[4:7], s51 offen offset:3072
  v_dot2c_f32_bf16 v72, s30, v220
  v_dot2c_f32_bf16 v73, v220, v220
  v_dot2c_f32_bf16 v74, s30, v221
  v_dot2c_f32_bf16 v75, v221, v221
  v_dot2c_f32_bf16 v72, s30, v222
  v_dot2c_f32_bf16 v73, v222, v222
  v_dot2c_f32_bf16 v74, s30, v223
  v_dot2c_f32_bf16 v75, v223, v223
  s_waitcnt vmcnt(12) lgkmcnt(5)
  v_mfma_f32_32x32x16_bf16 v[8:23], a[24:27], v[224:227], v[8:23]
  ds_read_b128 a[48:51], v4 offset:34816
  s_waitcnt lgkmcnt(5)
  v_mfma_f32_32x32x16_bf16 v[24:39], a[28:31], v[224:227], v[24:39]
  ds_read_b128 a[52:55], v6 offset:14336
  s_waitcnt lgkmcnt(5)
  v_mfma_f32_32x32x16_bf16 v[40:55], a[32:35], v[224:227], v[40:55]
  ds_read_b128 a[56:59], v6 offset:55296
  s_add_u32 m0, s20, 122880
  s_add_u32 s24, s46, 125952
  buffer_load_dwordx4 v1, s[4:7], s24 offen lds
  s_waitcnt vmcnt(12) lgkmcnt(5)
  v_mfma_f32_32x32x16_bf16 v[8:23], a[36:39], v[228:231], v[8:23]
  ds_read_b128 a[60:63], v4 offset:35840
  s_waitcnt lgkmcnt(5)
  v_mfma_f32_32x32x16_bf16 v[24:39], a[40:43], v[228:231], v[24:39]
  ds_read_b128 a[64:67], v6 offset:15360
  buffer_load_dwordx4 v1, s[4:7], s24 offen offset:1024 lds
  s_waitcnt lgkmcnt(5)
  v_mfma_f32_32x32x16_bf16 v[40:55], a[44:47], v[228:231], v[40:55]
  ds_read_b128 a[68:71], v6 offset:56320
  s_waitcnt vmcnt(12) lgkmcnt(5)
  v_mfma_f32_32x32x16_bf16 v[8:23], a[48:51], v[232:235], v[8:23]
  s_waitcnt vmcnt(7)
  s_barrier
  ds_read_b128 a[24:27], v4 offset:36864
  s_waitcnt lgkmcnt(5)
  v_mfma_f32_32x32x16_bf16 v[24:39], a[52:55], v[232:235], v[24:39]
  ds_read_b128 a[28:31], v6 offset:16384
  s_add_u32 m0, s20, 131072
  s_add_u32 s24, s47, 125952
  buffer_load_dwordx4 v1, s[4:7], s24 offen lds
  s_waitcnt lgkmcnt(5)
  v_mfma_f32_32x32x16_bf16 v[40:55], a[56:59], v[232:235], v[40:55]
  ds_read_b128 a[32:35], v6 offset:57344
  s_waitcnt lgkmcnt(5)
  v_mfma_f32_32x32x16_bf16 v[8:23], a[60:63], v[236:239], v[8:23]
  ds_read_b128 a[36:39], v4 offset:37888
  buffer_load_dwordx4 v1, s[4:7], s24 offen offset:1024 lds
  s_waitcnt lgkmcnt(5)
  v_mfma_f32_32x32x16_bf16 v[24:39], a[64:67], v[236:239], v[24:39]
  ds_read_b128 a[40:43], v6 offset:17408
  s_waitcnt lgkmcnt(5)
  v_mfma_f32_32x32x16_bf16 v[40:55], a[68:71], v[236:239], v[40:55]
  ds_read_b128 a[44:47], v6 offset:58368
  s_add_u32 s24, s17, 40960
  buffer_load_dwordx4 a[0:3], v4, s[4:7], s24 offen
  v_dot2c_f32_bf16 v72, s30, v224
  v_dot2c_f32_bf16 v73, v224, v224
  v_dot2c_f32_bf16 v74, s30, v225
  v_dot2c_f32_bf16 v75, v225, v225
  v_dot2c_f32_bf16 v72, s30, v226
  v_dot2c_f32_bf16 v73, v226, v226
  v_dot2c_f32_bf16 v74, s30, v227
  v_dot2c_f32_bf16 v75, v227, v227
  s_add_u32 s24, s17, 82944
  buffer_load_dwordx4 a[4:7], v4, s[4:7], s24 offen
  v_dot2c_f32_bf16 v72, s30, v228
  v_dot2c_f32_bf16 v73, v228, v228
  v_dot2c_f32_bf16 v74, s30, v229
  v_dot2c_f32_bf16 v75, v229, v229
  v_dot2c_f32_bf16 v72, s30, v230
  v_dot2c_f32_bf16 v73, v230, v230
  v_dot2c_f32_bf16 v74, s30, v231
  v_dot2c_f32_bf16 v75, v231, v231
  v_dot2c_f32_bf16 v72, s30, v232
  v_dot2c_f32_bf16 v73, v232, v232
  v_dot2c_f32_bf16 v74, s30, v233
  v_dot2c_f32_bf16 v75, v233, v233
  v_dot2c_f32_bf16 v72, s30, v234
  v_dot2c_f32_bf16 v73, v234, v234
  v_dot2c_f32_bf16 v74, s30, v235
  v_dot2c_f32_bf16 v75, v235, v235
  s_add_u32 s24, s17, 124928
  buffer_load_dwordx4 a[8:11], v4, s[4:7], s24 offen
  v_dot2c_f32_bf16 v72, s30, v236
  v_dot2c_f32_bf16 v73, v236, v236
  v_dot2c_f32_bf16 v74, s30, v237
  v_dot2c_f32_bf16 v75, v237, v237
  v_dot2c_f32_bf16 v72, s30, v238
  v_dot2c_f32_bf16 v73, v238, v238
  v_dot2c_f32_bf16 v74, s30, v239
  v_dot2c_f32_bf16 v75, v239, v239
  s_waitcnt vmcnt(11) lgkmcnt(5)
  v_mfma_f32_32x32x16_bf16 v[8:23], a[24:27], v[240:243], v[8:23]
  ds_read_b128 a[48:51], v4 offset:38912
  s_waitcnt lgkmcnt(5)
  v_mfma_f32_32x32x16_bf16 v[24:39], a[28:31], v[240:243], v[24:39]
  ds_read_b128 a[52:55], v6 offset:18432
  s_waitcnt lgkmcnt(5)
  v_mfma_f32_32x32x16_bf16 v[40:55], a[32:35], v[240:243], v[40:55]
  ds_read_b128 a[56:59], v6 offset:59392
  s_add_u32 m0, s20, 139264
  s_add_u32 s24, s48, 125952
  buffer_load_dwordx4 v1, s[4:7], s24 offen lds
  s_waitcnt vmcnt(11) lgkmcnt(5)
  v_mfma_f32_32x32x16_bf16 v[8:23], a[36:39], v[244:247], v[8:23]
  ds_read_b128 a[60:63], v4 offset:39936
  s_waitcnt lgkmcnt(5)
  v_mfma_f32_32x32x16_bf16 v[24:39], a[40:43], v[244:247], v[24:39]
  ds_read_b128 a[64:67], v6 offset:19456
  buffer_load_dwordx4 v1, s[4:7], s24 offen offset:1024 lds
  s_waitcnt lgkmcnt(5)
  v_mfma_f32_32x32x16_bf16 v[40:55], a[44:47], v[244:247], v[40:55]
  ds_read_b128 a[68:71], v6 offset:60416
  s_waitcnt vmcnt(11) lgkmcnt(5)
  v_mfma_f32_32x32x16_bf16 v[8:23], a[48:51], v[248:251], v[8:23]
  s_waitcnt vmcnt(7)
  s_barrier
  ds_read_b128 a[24:27], v7 offset:0
  s_waitcnt lgkmcnt(5)
  v_mfma_f32_32x32x16_bf16 v[24:39], a[52:55], v[248:251], v[24:39]
  ds_read_b128 a[28:31], v7 offset:1024
  s_add_u32 m0, s20, 147456
  s_add_u32 s24, s49, 125952
  buffer_load_dwordx4 v1, s[4:7], s24 offen lds
  s_waitcnt lgkmcnt(5)
  v_mfma_f32_32x32x16_bf16 v[40:55], a[56:59], v[248:251], v[40:55]
  ds_read_b128 a[32:35], v7 offset:2048
  s_waitcnt lgkmcnt(5)
  v_mfma_f32_32x32x16_bf16 v[8:23], a[60:63], v[252:255], v[8:23]
  ds_read_b128 a[36:39], v7 offset:3072
  buffer_load_dwordx4 v1, s[4:7], s24 offen offset:1024 lds
  s_waitcnt lgkmcnt(5)
  v_mfma_f32_32x32x16_bf16 v[24:39], a[64:67], v[252:255], v[24:39]
  ds_read_b128 a[40:43], v7 offset:4096
  s_waitcnt lgkmcnt(5)
  v_mfma_f32_32x32x16_bf16 v[40:55], a[68:71], v[252:255], v[40:55]
  ds_read_b128 a[44:47], v7 offset:5120
  s_add_u32 m0, s20, 155648
  s_add_u32 s24, s50, 125952
  buffer_load_dwordx4 v1, s[4:7], s24 offen lds
  v_dot2c_f32_bf16 v72, s30, v240
  v_dot2c_f32_bf16 v73, v240, v240
  v_dot2c_f32_bf16 v74, s30, v241
  v_dot2c_f32_bf16 v75, v241, v241
  v_dot2c_f32_bf16 v72, s30, v242
  v_dot2c_f32_bf16 v73, v242, v242
  v_dot2c_f32_bf16 v74, s30, v243
  v_dot2c_f32_bf16 v75, v243, v243
  buffer_load_dwordx4 v1, s[4:7], s24 offen offset:1024 lds
  v_dot2c_f32_bf16 v72, s30, v244
  v_dot2c_f32_bf16 v73, v244, v244
  v_dot2c_f32_bf16 v74, s30, v245
  v_dot2c_f32_bf16 v75, v245, v245
  v_dot2c_f32_bf16 v72, s30, v246
  v_dot2c_f32_bf16 v73, v246, v246
  v_dot2c_f32_bf16 v74, s30, v247
  v_dot2c_f32_bf16 v75, v247, v247
  v_dot2c_f32_bf16 v72, s30, v248
  v_dot2c_f32_bf16 v73, v248, v248
  v_dot2c_f32_bf16 v74, s30, v249
  v_dot2c_f32_bf16 v75, v249, v249
  v_dot2c_f32_bf16 v72, s30, v250
  v_dot2c_f32_bf16 v73, v250, v250
  v_dot2c_f32_bf16 v74, s30, v251
  v_dot2c_f32_bf16 v75, v251, v251
  s_add_u32 s24, s17, 166912
  buffer_load_dwordx4 a[12:15], v4, s[4:7], s24 offen
  v_dot2c_f32_bf16 v72, s30, v252
  v_dot2c_f32_bf16 v73, v252, v252
  v_dot2c_f32_bf16 v74, s30, v253
  v_dot2c_f32_bf16 v75, v253, v253
  v_dot2c_f32_bf16 v72, s30, v254
  v_dot2c_f32_bf16 v73, v254, v254
  v_dot2c_f32_bf16 v74, s30, v255
  v_dot2c_f32_bf16 v75, v255, v255
  s_waitcnt lgkmcnt(5)
  v_mfma_f32_32x32x16_bf16 v[56:71], a[24:27], v[96:99], 0
  ds_read_b128 a[48:51], v7 offset:6144
  s_add_u32 m0, s20, 0
  s_add_u32 s24, s46, 167936
  buffer_load_dwordx4 v1, s[4:7], s24 offen lds
  v_add_f32 v72, v72, v74
  v_add_f32 v73, v73, v75
  s_waitcnt lgkmcnt(5)
  v_mfma_f32_32x32x16_bf16 v[56:71], a[28:31], v[100:103], v[56:71]
  ds_read_b128 a[52:55], v7 offset:7168
  v_mov_b32 v74, v72
  v_mov_b32 v75, v73
  s_mul_i32 s26, s21, 96
  s_mul_i32 s27, s14, 6
  v_permlane32_swap_b32 v72, v74
  s_waitcnt lgkmcnt(5)
  v_mfma_f32_32x32x16_bf16 v[56:71], a[32:35], v[104:107], v[56:71]
  s_waitcnt vmcnt(11)
  s_barrier
  ds_read_b128 a[56:59], v7 offset:8192
  buffer_load_dwordx4 v1, s[4:7], s24 offen offset:1024 lds
  v_permlane32_swap_b32 v73, v75
  v_add_f32 v72, v72, v74
  s_waitcnt lgkmcnt(5)
  v_mfma_f32_32x32x16_bf16 v[56:71], a[36:39], v[108:111], v[56:71]
  ds_read_b128 a[60:63], v7 offset:9216
  v_add_f32 v73, v73, v75
  v_mul_f32 v72, 0xbacccccd, v72
  v_mul_f32 v73, 0x3acccccd, v73
  v_cvt_pk_bf16_f32 v76, v72, v72
  v_fma_f32 v73, -v72, v72, v73
  s_waitcnt lgkmcnt(5)
  v_mfma_f32_32x32x16_bf16 v[56:71], a[40:43], v[112:115], v[56:71]
  ds_read_b128 a[64:67], v7 offset:10240
  s_add_u32 m0, s20, 8192
  s_add_u32 s24, s47, 167936
  buffer_load_dwordx4 v1, s[4:7], s24 offen lds
  v_mov_b32 v77, v76
  v_mov_b32 v78, v76
  s_waitcnt lgkmcnt(5)
  v_mfma_f32_32x32x16_bf16 v[56:71], a[44:47], v[116:119], v[56:71]
  ds_read_b128 a[68:71], v7 offset:11264
  v_mov_b32 v79, v76
  v_max_f32 v73, 0, v73
  v_cvt_pk_bf16_f32 v73, v73, v73
  s_waitcnt vmcnt(12)
  v_mfma_f32_32x32x16_bf16 v[8:23], a[0:3], v[76:79], v[8:23]
  s_waitcnt vmcnt(11)
  v_mfma_f32_32x32x16_bf16 v[24:39], a[4:7], v[76:79], v[24:39]
  s_waitcnt vmcnt(10)
  v_mfma_f32_32x32x16_bf16 v[40:55], a[8:11], v[76:79], v[40:55]
  v_and_b32 v73, 0xffff0000, v73
  v_add_f32 v73, 0x3727c5ac, v73
  v_cvt_pk_bf16_f32 v73, v73, v73
  v_and_b32 v73, 0xffff0000, v73
  v_sqrt_f32 v73, v73
  s_waitcnt lgkmcnt(5)
  v_mfma_f32_32x32x16_bf16 v[56:71], a[48:51], v[120:123], v[56:71]
  ds_read_b128 a[24:27], v7 offset:12288
  buffer_load_dwordx4 v1, s[4:7], s24 offen offset:1024 lds
  s_add_u32 s26, s26, s27
  v_cvt_pk_bf16_f32 v73, v73, v73
  v_and_b32 v73, 0xffff0000, v73
  v_rcp_f32 v72, v73
  s_waitcnt lgkmcnt(5)
  v_mfma_f32_32x32x16_bf16 v[56:71], a[52:55], v[124:127], v[56:71]
  ds_read_b128 a[28:31], v7 offset:13312
  v_mul_f32 v82, v73, v73
  v_mul_f32 v80, 0xc0135761, v72
  v_mul_f32 v81, v72, v72
  v_mul_f32 v81, 0x3d372713, v81
  v_mul_f32 v81, v81, v80
  s_waitcnt lgkmcnt(5)
  v_mfma_f32_32x32x16_bf16 v[56:71], a[56:59], v[128:131], v[56:71]
  ds_read_b128 a[32:35], v7 offset:14336
  s_add_u32 m0, s20, 16384
  s_add_u32 s24, s48, 167936
  buffer_load_dwordx4 v1, s[4:7], s24 offen lds
  s_lshl_b32 s26, s26, 10
  s_add_u32 s26, s26, 13205504
  s_waitcnt lgkmcnt(5)
  v_mfma_f32_32x32x16_bf16 v[56:71], a[60:63], v[132:135], v[56:71]
  ds_read_b128 a[36:39], v7 offset:15360
  s_add_u32 s27, s26, 4096
  v_mul_f32 v84, v8, v8
  v_mul_f32 v85, v9, v9
  v_mul_f32 v86, v10, v10
  v_mul_f32 v87, v11, v11
  s_waitcnt lgkmcnt(5)
  v_mfma_f32_32x32x16_bf16 v[56:71], a[64:67], v[136:139], v[56:71]
  s_waitcnt vmcnt(10)
  s_barrier
  ds_read_b128 a[40:43], v7 offset:16384
  buffer_load_dwordx4 v1, s[4:7], s24 offen offset:1024 lds
  v_fma_f32 v84, v84, v81, v80
  v_fma_f32 v85, v85, v81, v80
  s_waitcnt lgkmcnt(5)
  v_mfma_f32_32x32x16_bf16 v[56:71], a[68:71], v[140:143], v[56:71]
  ds_read_b128 a[44:47], v7 offset:17408
  v_fma_f32 v86, v86, v81, v80
  v_fma_f32 v87, v87, v81, v80
  v_mul_f32 v84, v84, v8
  v_mul_f32 v85, v85, v9
  v_mul_f32 v86, v86, v10
  s_waitcnt lgkmcnt(5)
  v_mfma_f32_32x32x16_bf16 v[56:71], a[24:27], v[144:147], v[56:71]
  ds_read_b128 a[48:51], v7 offset:18432
  s_add_u32 m0, s20, 24576
  s_add_u32 s24, s49, 167936
  buffer_load_dwordx4 v1, s[4:7], s24 offen lds
  v_mul_f32 v87, v87, v11
  v_exp_f32 v84, v84
  s_waitcnt lgkmcnt(5)
  v_mfma_f32_32x32x16_bf16 v[56:71], a[28:31], v[148:151], v[56:71]
  ds_read_b128 a[52:55], v7 offset:19456
  v_exp_f32 v85, v85
  v_exp_f32 v86, v86
  v_exp_f32 v87, v87
  s_waitcnt lgkmcnt(5)
  v_mfma_f32_32x32x16_bf16 v[56:71], a[32:35], v[152:155], v[56:71]
  ds_read_b128 a[56:59], v7 offset:20480
  buffer_load_dwordx4 v1, s[4:7], s24 offen offset:1024 lds
  v_mul_f32 v88, v8, v16
  v_mul_f32 v89, v9, v17
  v_mul_f32 v90, v10, v18
  v_mul_f32 v91, v11, v19
  s_waitcnt lgkmcnt(5)
  v_mfma_f32_32x32x16_bf16 v[56:71], a[36:39], v[156:159], v[56:71]
  ds_read_b128 a[60:63], v7 offset:21504
  v_fma_f32 v84, v84, v82, v82
  v_fma_f32 v85, v85, v82, v82
  v_fma_f32 v86, v86, v82, v82
  v_fma_f32 v87, v87, v82, v82
  v_rcp_f32 v84, v84
  s_waitcnt lgkmcnt(5)
  v_mfma_f32_32x32x16_bf16 v[56:71], a[40:43], v[160:163], v[56:71]
  ds_read_b128 a[64:67], v7 offset:22528
  s_add_u32 m0, s20, 32768
  s_add_u32 s24, s50, 167936
  buffer_load_dwordx4 v1, s[4:7], s24 offen lds
  v_rcp_f32 v85, v85
  s_waitcnt lgkmcnt(5)
  v_mfma_f32_32x32x16_bf16 v[56:71], a[44:47], v[164:167], v[56:71]
  ds_read_b128 a[68:71], v7 offset:23552
  v_rcp_f32 v86, v86
  v_rcp_f32 v87, v87
  v_mul_f32 v88, v88, v84
  s_waitcnt lgkmcnt(5)
  v_mfma_f32_32x32x16_bf16 v[56:71], a[48:51], v[168:171], v[56:71]
  s_waitcnt vmcnt(10)
  s_barrier
  ds_read_b128 a[24:27], v7 offset:24576
  buffer_load_dwordx4 v1, s[4:7], s24 offen offset:1024 lds
  v_mul_f32 v89, v89, v85
  v_mul_f32 v90, v90, v86
  s_waitcnt lgkmcnt(5)
  v_mfma_f32_32x32x16_bf16 v[56:71], a[52:55], v[172:175], v[56:71]
  ds_read_b128 a[28:31], v7 offset:25600
  v_mul_f32 v91, v91, v87
  v_cvt_pk_bf16_f32 v92, v88, v89
  v_cvt_pk_bf16_f32 v93, v90, v91
  v_mul_f32 v84, v12, v12
  v_mul_f32 v85, v13, v13
  s_waitcnt lgkmcnt(5)
  v_mfma_f32_32x32x16_bf16 v[56:71], a[56:59], v[176:179], v[56:71]
  ds_read_b128 a[32:35], v7 offset:26624
  s_add_u32 s24, s17, 208896
  buffer_load_dwordx4 a[16:19], v4, s[4:7], s24 offen
  v_mul_f32 v86, v14, v14
  v_mul_f32 v87, v15, v15
  v_fma_f32 v84, v84, v81, v80
  s_waitcnt lgkmcnt(5)
  v_mfma_f32_32x32x16_bf16 v[56:71], a[60:63], v[180:183], v[56:71]
  ds_read_b128 a[36:39], v7 offset:27648
  v_fma_f32 v85, v85, v81, v80
  v_fma_f32 v86, v86, v81, v80
  v_fma_f32 v87, v87, v81, v80
  v_mul_f32 v84, v84, v12
  v_mul_f32 v85, v85, v13
  s_waitcnt lgkmcnt(5)
  v_mfma_f32_32x32x16_bf16 v[56:71], a[64:67], v[184:187], v[56:71]
  ds_read_b128 a[40:43], v7 offset:28672
  s_add_u32 m0, s20, 40960
  s_add_u32 s24, s46, 209920
  buffer_load_dwordx4 v1, s[4:7], s24 offen lds
  v_mul_f32 v86, v86, v14
  v_mul_f32 v87, v87, v15
  s_waitcnt lgkmcnt(5)
  v_mfma_f32_32x32x16_bf16 v[56:71], a[68:71], v[188:191], v[56:71]
  ds_read_b128 a[44:47], v7 offset:29696
  v_exp_f32 v84, v84
  v_exp_f32 v85, v85
  v_exp_f32 v86, v86
  s_waitcnt lgkmcnt(5)
  v_mfma_f32_32x32x16_bf16 v[56:71], a[24:27], v[192:195], v[56:71]
  ds_read_b128 a[48:51], v7 offset:30720
  buffer_load_dwordx4 v1, s[4:7], s24 offen offset:1024 lds
  v_exp_f32 v87, v87
  v_mul_f32 v88, v12, v20
  v_mul_f32 v89, v13, v21
  s_waitcnt lgkmcnt(5)
  v_mfma_f32_32x32x16_bf16 v[56:71], a[28:31], v[196:199], v[56:71]
  ds_read_b128 a[52:55], v7 offset:31744
  v_mul_f32 v90, v14, v22
  v_mul_f32 v91, v15, v23
  v_fma_f32 v84, v84, v82, v82
  v_fma_f32 v85, v85, v82, v82
  v_fma_f32 v86, v86, v82, v82
  s_waitcnt lgkmcnt(5)
  v_mfma_f32_32x32x16_bf16 v[56:71], a[32:35], v[200:203], v[56:71]
  ds_read_b128 a[56:59], v7 offset:32768
  s_add_u32 m0, s20, 49152
  s_add_u32 s24, s47, 209920
  buffer_load_dwordx4 v1, s[4:7], s24 offen lds
  v_fma_f32 v87, v87, v82, v82
  v_rcp_f32 v84, v84
  s_waitcnt lgkmcnt(5)
  v_mfma_f32_32x32x16_bf16 v[56:71], a[36:39], v[204:207], v[56:71]
  ds_read_b128 a[60:63], v7 offset:33792
  v_rcp_f32 v85, v85
  v_rcp_f32 v86, v86
  v_rcp_f32 v87, v87
  s_waitcnt lgkmcnt(5)
  v_mfma_f32_32x32x16_bf16 v[56:71], a[40:43], v[208:211], v[56:71]
  ds_read_b128 a[64:67], v7 offset:34816
  buffer_load_dwordx4 v1, s[4:7], s24 offen offset:1024 lds
  v_mul_f32 v88, v88, v84
  v_mul_f32 v89, v89, v85
  v_mul_f32 v90, v90, v86
  v_mul_f32 v91, v91, v87
  s_waitcnt lgkmcnt(5)
  v_mfma_f32_32x32x16_bf16 v[56:71], a[44:47], v[212:215], v[56:71]
  ds_read_b128 a[68:71], v7 offset:35840
  v_cvt_pk_bf16_f32 v94, v88, v89
  v_cvt_pk_bf16_f32 v95, v90, v91
  buffer_store_dwordx4 v[92:95], v4, s[4:7], s26 offen offset:0 sc1
  v_mul_f32 v84, v24, v24
  v_mul_f32 v85, v25, v25
  s_waitcnt lgkmcnt(5)
  v_mfma_f32_32x32x16_bf16 v[56:71], a[48:51], v[216:219], v[56:71]
  ds_read_b128 a[24:27], v7 offset:36864
  s_add_u32 m0, s20, 57344
  s_add_u32 s24, s48, 209920
  buffer_load_dwordx4 v1, s[4:7], s24 offen lds
  v_mul_f32 v86, v26, v26
  v_mul_f32 v87, v27, v27
  s_waitcnt lgkmcnt(5)
  v_mfma_f32_32x32x16_bf16 v[56:71], a[52:55], v[220:223], v[56:71]
  ds_read_b128 a[28:31], v7 offset:37888
  v_fma_f32 v84, v84, v81, v80
  v_fma_f32 v85, v85, v81, v80
  v_fma_f32 v86, v86, v81, v80
  v_fma_f32 v87, v87, v81, v80
  v_mul_f32 v84, v84, v24
  s_waitcnt lgkmcnt(5)
  v_mfma_f32_32x32x16_bf16 v[56:71], a[56:59], v[224:227], v[56:71]
  ds_read_b128 a[32:35], v7 offset:38912
  buffer_load_dwordx4 v1, s[4:7], s24 offen offset:1024 lds
  v_mul_f32 v85, v85, v25
  v_mul_f32 v86, v86, v26
  v_mul_f32 v87, v87, v27
  v_exp_f32 v84, v84
  s_waitcnt lgkmcnt(5)
  v_mfma_f32_32x32x16_bf16 v[56:71], a[60:63], v[228:231], v[56:71]
  ds_read_b128 a[36:39], v7 offset:39936
  v_exp_f32 v85, v85
  v_exp_f32 v86, v86
  v_exp_f32 v87, v87
  s_waitcnt lgkmcnt(5)
  v_mfma_f32_32x32x16_bf16 v[56:71], a[64:67], v[232:235], v[56:71]
  s_waitcnt vmcnt(14)
  s_barrier
  ds_read_b128 a[40:43], v4 offset:0
  s_add_u32 m0, s20, 65536
  s_add_u32 s24, s49, 209920
  buffer_load_dwordx4 v1, s[4:7], s24 offen lds
  s_waitcnt lgkmcnt(5)
  v_mfma_f32_32x32x16_bf16 v[56:71], a[68:71], v[236:239], v[56:71]
  ds_read_b128 a[44:47], v4 offset:1024
  v_mul_f32 v88, v24, v32
  v_mul_f32 v89, v25, v33
  v_mul_f32 v90, v26, v34
  v_mul_f32 v91, v27, v35
  v_fma_f32 v84, v84, v82, v82
  s_waitcnt lgkmcnt(5)
  v_mfma_f32_32x32x16_bf16 v[56:71], a[24:27], v[240:243], v[56:71]
  ds_read_b128 a[48:51], v4 offset:2048
  buffer_load_dwordx4 v1, s[4:7], s24 offen offset:1024 lds
  v_fma_f32 v85, v85, v82, v82
  v_fma_f32 v86, v86, v82, v82
  v_fma_f32 v87, v87, v82, v82
  v_rcp_f32 v84, v84
  s_waitcnt lgkmcnt(5)
  v_mfma_f32_32x32x16_bf16 v[56:71], a[28:31], v[244:247], v[56:71]
  ds_read_b128 a[52:55], v4 offset:3072
  v_rcp_f32 v85, v85
  v_rcp_f32 v86, v86
  v_rcp_f32 v87, v87
  s_waitcnt lgkmcnt(5)
  v_mfma_f32_32x32x16_bf16 v[56:71], a[32:35], v[248:251], v[56:71]
  ds_read_b128 a[56:59], v4 offset:4096
  s_add_u32 m0, s20, 73728
  s_add_u32 s24, s50, 209920
  buffer_load_dwordx4 v1, s[4:7], s24 offen lds
  v_mul_f32 v88, v88, v84
  v_mul_f32 v89, v89, v85
  s_waitcnt lgkmcnt(5)
  v_mfma_f32_32x32x16_bf16 v[56:71], a[36:39], v[252:255], v[56:71]
  ds_read_b128 a[60:63], v4 offset:5120
  v_mul_f32 v90, v90, v86
  v_mul_f32 v91, v91, v87
  v_cvt_pk_bf16_f32 v92, v88, v89
  v_cvt_pk_bf16_f32 v93, v90, v91
  v_mul_f32 v84, v28, v28
  v_mfma_f32_32x32x16_bf16 v[56:71], a[12:15], v[76:79], v[56:71]
  s_waitcnt lgkmcnt(5)
  v_mfma_f32_32x32x16_bf16 v[8:23], a[40:43], v[96:99], 0
  ds_read_b128 a[64:67], v4 offset:6144
  buffer_load_dwordx4 v1, s[4:7], s24 offen offset:1024 lds
  v_mul_f32 v85, v29, v29
  v_mul_f32 v86, v30, v30
  v_mul_f32 v87, v31, v31
  v_fma_f32 v84, v84, v81, v80
  s_waitcnt lgkmcnt(5)
  v_mfma_f32_32x32x16_bf16 v[8:23], a[44:47], v[100:103], v[8:23]
  ds_read_b128 a[68:71], v4 offset:7168
  v_fma_f32 v85, v85, v81, v80
  v_fma_f32 v86, v86, v81, v80
  v_fma_f32 v87, v87, v81, v80
  v_mul_f32 v84, v84, v28
  v_mul_f32 v85, v85, v29
  s_waitcnt lgkmcnt(5)
  v_mfma_f32_32x32x16_bf16 v[8:23], a[48:51], v[104:107], v[8:23]
  ds_read_b128 a[24:27], v4 offset:8192
  s_add_u32 s24, s17, 250880
  buffer_load_dwordx4 a[20:23], v4, s[4:7], s24 offen
  v_mul_f32 v86, v86, v30
  v_mul_f32 v87, v87, v31
  v_exp_f32 v84, v84
  s_waitcnt lgkmcnt(5)
  v_mfma_f32_32x32x16_bf16 v[8:23], a[52:55], v[108:111], v[8:23]
  ds_read_b128 a[28:31], v4 offset:9216
  v_exp_f32 v85, v85
  v_exp_f32 v86, v86
  v_exp_f32 v87, v87
  s_waitcnt lgkmcnt(5)
  v_mfma_f32_32x32x16_bf16 v[8:23], a[56:59], v[112:115], v[8:23]
  ds_read_b128 a[32:35], v4 offset:10240
  s_add_u32 s51, s70, 8192
  buffer_load_dwordx4 a[104:107], v4, s[4:7], s51 offen offset:0
  v_mul_f32 v88, v28, v36
  v_mul_f32 v89, v29, v37
  v_mul_f32 v90, v30, v38
  s_waitcnt lgkmcnt(5)
  v_mfma_f32_32x32x16_bf16 v[8:23], a[60:63], v[116:119], v[8:23]
  ds_read_b128 a[36:39], v4 offset:11264
  v_mul_f32 v91, v31, v39
  v_fma_f32 v84, v84, v82, v82
  v_fma_f32 v85, v85, v82, v82
  v_fma_f32 v86, v86, v82, v82
  v_fma_f32 v87, v87, v82, v82
  s_waitcnt lgkmcnt(5)
  v_mfma_f32_32x32x16_bf16 v[8:23], a[64:67], v[120:123], v[8:23]
  ds_read_b128 a[40:43], v4 offset:12288
  buffer_load_dwordx4 a[108:111], v4, s[4:7], s51 offen offset:1024
  v_rcp_f32 v84, v84
  v_rcp_f32 v85, v85
  s_waitcnt lgkmcnt(5)
  v_mfma_f32_32x32x16_bf16 v[8:23], a[68:71], v[124:127], v[8:23]
  ds_read_b128 a[44:47], v4 offset:13312
  v_rcp_f32 v86, v86
  v_rcp_f32 v87, v87
  v_mul_f32 v88, v88, v84
  s_waitcnt lgkmcnt(5)
  v_mfma_f32_32x32x16_bf16 v[8:23], a[24:27], v[128:131], v[8:23]
  ds_read_b128 a[48:51], v4 offset:14336
  buffer_load_dwordx4 a[112:115], v4, s[4:7], s51 offen offset:2048
  v_mul_f32 v89, v89, v85
  v_mul_f32 v90, v90, v86
  v_mul_f32 v91, v91, v87
  v_cvt_pk_bf16_f32 v94, v88, v89
  s_waitcnt lgkmcnt(5)
  v_mfma_f32_32x32x16_bf16 v[8:23], a[28:31], v[132:135], v[8:23]
  ds_read_b128 a[52:55], v4 offset:15360
  v_cvt_pk_bf16_f32 v95, v90, v91
  buffer_store_dwordx4 v[92:95], v4, s[4:7], s26 offen offset:1024 sc1
  v_mul_f32 v84, v40, v40
  v_mul_f32 v85, v41, v41
  v_mul_f32 v86, v42, v42
  s_waitcnt lgkmcnt(5)
  v_mfma_f32_32x32x16_bf16 v[8:23], a[32:35], v[136:139], v[8:23]
  s_waitcnt vmcnt(17)
  s_barrier
  ds_read_b128 a[56:59], v4 offset:16384
  buffer_load_dwordx4 a[116:119], v4, s[4:7], s51 offen offset:3072
  v_mul_f32 v87, v43, v43
  v_fma_f32 v84, v84, v81, v80
  s_waitcnt lgkmcnt(5)
  v_mfma_f32_32x32x16_bf16 v[8:23], a[36:39], v[140:143], v[8:23]
  ds_read_b128 a[60:63], v4 offset:17408
  v_fma_f32 v85, v85, v81, v80
  v_fma_f32 v86, v86, v81, v80
  v_fma_f32 v87, v87, v81, v80
  v_mul_f32 v84, v84, v40
  v_mul_f32 v85, v85, v41
  s_waitcnt lgkmcnt(5)
  v_mfma_f32_32x32x16_bf16 v[8:23], a[40:43], v[144:147], v[8:23]
  ds_read_b128 a[64:67], v4 offset:18432
  s_add_u32 s51, s70, 12288
  buffer_load_dwordx4 a[120:123], v4, s[4:7], s51 offen offset:0
  v_mul_f32 v86, v86, v42
  v_mul_f32 v87, v87, v43
  v_exp_f32 v84, v84
  s_waitcnt lgkmcnt(5)
  v_mfma_f32_32x32x16_bf16 v[8:23], a[44:47], v[148:151], v[8:23]
  ds_read_b128 a[68:71], v4 offset:19456
  v_exp_f32 v85, v85
  v_exp_f32 v86, v86
  v_exp_f32 v87, v87
  s_waitcnt lgkmcnt(5)
  v_mfma_f32_32x32x16_bf16 v[8:23], a[48:51], v[152:155], v[8:23]
  ds_read_b128 a[24:27], v4 offset:20480
  buffer_load_dwordx4 a[124:127], v4, s[4:7], s51 offen offset:1024
  v_mul_f32 v88, v40, v48
  v_mul_f32 v89, v41, v49
  v_mul_f32 v90, v42, v50
  v_mul_f32 v91, v43, v51
  s_waitcnt lgkmcnt(5)
  v_mfma_f32_32x32x16_bf16 v[8:23], a[52:55], v[156:159], v[8:23]
  ds_read_b128 a[28:31], v4 offset:21504
  v_fma_f32 v84, v84, v82, v82
  v_fma_f32 v85, v85, v82, v82
  v_fma_f32 v86, v86, v82, v82
  v_fma_f32 v87, v87, v82, v82
  v_rcp_f32 v84, v84
  s_waitcnt lgkmcnt(5)
  v_mfma_f32_32x32x16_bf16 v[8:23], a[56:59], v[160:163], v[8:23]
  ds_read_b128 a[32:35], v4 offset:22528
  buffer_load_dwordx4 a[128:131], v4, s[4:7], s51 offen offset:2048
  v_rcp_f32 v85, v85
  v_rcp_f32 v86, v86
  s_waitcnt lgkmcnt(5)
  v_mfma_f32_32x32x16_bf16 v[8:23], a[60:63], v[164:167], v[8:23]
  ds_read_b128 a[36:39], v4 offset:23552
  v_rcp_f32 v87, v87
  v_mul_f32 v88, v88, v84
  v_mul_f32 v89, v89, v85
  v_mul_f32 v90, v90, v86
  s_waitcnt lgkmcnt(5)
  v_mfma_f32_32x32x16_bf16 v[8:23], a[64:67], v[168:171], v[8:23]
  ds_read_b128 a[40:43], v4 offset:24576
  s_add_u32 s51, s71, 0
  buffer_load_dwordx4 a[132:135], v4, s[4:7], s51 offen offset:0
  v_mul_f32 v91, v91, v87
  v_cvt_pk_bf16_f32 v92, v88, v89
  v_cvt_pk_bf16_f32 v93, v90, v91
  s_waitcnt lgkmcnt(5)
  v_mfma_f32_32x32x16_bf16 v[8:23], a[68:71], v[172:175], v[8:23]
  ds_read_b128 a[44:47], v4 offset:25600
  v_mul_f32 v84, v44, v44
  v_mul_f32 v85, v45, v45
  v_mul_f32 v86, v46, v46
  v_mul_f32 v87, v47, v47
  v_fma_f32 v84, v84, v81, v80
  s_waitcnt lgkmcnt(5)
  v_mfma_f32_32x32x16_bf16 v[8:23], a[24:27], v[176:179], v[8:23]
  ds_read_b128 a[48:51], v4 offset:26624
  buffer_load_dwordx4 a[136:139], v4, s[4:7], s51 offen offset:1024
  v_fma_f32 v85, v85, v81, v80
  v_fma_f32 v86, v86, v81, v80
  v_fma_f32 v87, v87, v81, v80
  v_mul_f32 v84, v84, v44
  s_waitcnt lgkmcnt(5)
  v_mfma_f32_32x32x16_bf16 v[8:23], a[28:31], v[180:183], v[8:23]
  ds_read_b128 a[52:55], v4 offset:27648
  v_mul_f32 v85, v85, v45
  v_mul_f32 v86, v86, v46
  v_mul_f32 v87, v87, v47
  v_exp_f32 v84, v84
  s_waitcnt lgkmcnt(5)
  v_mfma_f32_32x32x16_bf16 v[8:23], a[32:35], v[184:187], v[8:23]
  ds_read_b128 a[56:59], v4 offset:28672
  buffer_load_dwordx4 a[140:143], v4, s[4:7], s51 offen offset:2048
  v_exp_f32 v85, v85
  v_exp_f32 v86, v86
  s_waitcnt lgkmcnt(5)
  v_mfma_f32_32x32x16_bf16 v[8:23], a[36:39], v[188:191], v[8:23]
  ds_read_b128 a[60:63], v4 offset:29696
  v_exp_f32 v87, v87
  v_mul_f32 v88, v44, v52
  v_mul_f32 v89, v45, v53
  v_mul_f32 v90, v46, v54
  s_waitcnt lgkmcnt(5)
  v_mfma_f32_32x32x16_bf16 v[8:23], a[40:43], v[192:195], v[8:23]
  ds_read_b128 a[64:67], v4 offset:30720
  buffer_load_dwordx4 a[144:147], v4, s[4:7], s51 offen offset:3072
  v_mul_f32 v91, v47, v55
  v_fma_f32 v84, v84, v82, v82
  v_fma_f32 v85, v85, v82, v82
  v_fma_f32 v86, v86, v82, v82
  s_waitcnt lgkmcnt(5)
  v_mfma_f32_32x32x16_bf16 v[8:23], a[44:47], v[196:199], v[8:23]
  ds_read_b128 a[68:71], v4 offset:31744
  v_fma_f32 v87, v87, v82, v82
  v_rcp_f32 v84, v84
  v_rcp_f32 v85, v85
  s_waitcnt lgkmcnt(5)
  v_mfma_f32_32x32x16_bf16 v[8:23], a[48:51], v[200:203], v[8:23]
  ds_read_b128 a[24:27], v4 offset:32768
  s_add_u32 s51, s71, 4096
  buffer_load_dwordx4 a[148:151], v4, s[4:7], s51 offen offset:0
  v_rcp_f32 v86, v86
  v_rcp_f32 v87, v87
  s_waitcnt lgkmcnt(5)
  v_mfma_f32_32x32x16_bf16 v[8:23], a[52:55], v[204:207], v[8:23]
  ds_read_b128 a[28:31], v4 offset:33792
  v_mul_f32 v88, v88, v84
  v_mul_f32 v89, v89, v85
  v_mul_f32 v90, v90, v86
  v_mul_f32 v91, v91, v87
  v_cvt_pk_bf16_f32 v94, v88, v89
  s_waitcnt lgkmcnt(5)
  v_mfma_f32_32x32x16_bf16 v[8:23], a[56:59], v[208:211], v[8:23]
  ds_read_b128 a[32:35], v4 offset:34816
  v_and_b32 v2, 15, v0
  v_lshrrev_b32 v3, 4, v0
  v_lshlrev_b32 v5, 15, v3
  v_lshl_add_u32 v5, v2, 4, v5
  buffer_load_dwordx4 a[0:3], v5, s[4:7], s36 offen
  s_waitcnt lgkmcnt(5)
  v_mfma_f32_32x32x16_bf16 v[8:23], a[60:63], v[212:215], v[8:23]
  ds_read_b128 a[36:39], v4 offset:35840
  v_cvt_pk_bf16_f32 v95, v90, v91
  buffer_store_dwordx4 v[92:95], v4, s[4:7], s26 offen offset:2048 sc1
  v_mul_f32 v84, v56, v56
  v_mul_f32 v85, v57, v57
  v_mul_f32 v86, v58, v58
  s_waitcnt lgkmcnt(5)
  v_mfma_f32_32x32x16_bf16 v[8:23], a[64:67], v[216:219], v[8:23]
  ds_read_b128 a[40:43], v4 offset:36864
  buffer_load_dwordx4 a[4:7], v5, s[4:7], s37 offen
  v_mul_f32 v87, v59, v59
  v_fma_f32 v84, v84, v81, v80
  v_fma_f32 v85, v85, v81, v80
  v_fma_f32 v86, v86, v81, v80
  s_waitcnt lgkmcnt(5)
  v_mfma_f32_32x32x16_bf16 v[8:23], a[68:71], v[220:223], v[8:23]
  ds_read_b128 a[44:47], v4 offset:37888
  v_fma_f32 v87, v87, v81, v80
  v_mul_f32 v84, v84, v56
  v_mul_f32 v85, v85, v57
  v_mul_f32 v86, v86, v58
  v_mul_f32 v87, v87, v59
  s_waitcnt lgkmcnt(5)
  v_mfma_f32_32x32x16_bf16 v[8:23], a[24:27], v[224:227], v[8:23]
  ds_read_b128 a[48:51], v4 offset:38912
  v_lshrrev_b32 v5, 1, v3
  v_lshlrev_b32 v5, 15, v5
  v_lshl_add_u32 v5, v2, 4, v5
  v_and_b32 v1, 1, v3
  v_lshl_add_u32 v5, v1, 3, v5
  buffer_load_dwordx2 a[8:9], v5, s[4:7], s31 offen
  s_waitcnt lgkmcnt(5)
  v_mfma_f32_32x32x16_bf16 v[8:23], a[28:31], v[228:231], v[8:23]
  ds_read_b128 a[52:55], v4 offset:39936
  v_exp_f32 v84, v84
  v_exp_f32 v85, v85
  v_exp_f32 v86, v86
  s_waitcnt lgkmcnt(5)
  v_mfma_f32_32x32x16_bf16 v[8:23], a[32:35], v[232:235], v[8:23]
  s_waitcnt vmcnt(25)
  s_barrier
  ds_read_b128 a[56:59], v4 offset:40960
  v_lshlrev_b32 v5, 9, v3
  v_lshl_add_u32 v5, v2, 4, v5
  v_add_u32 v1, 4096, v5
  buffer_load_dwordx4 a[152:155], v4, s[4:7], s51 offen offset:1024
  s_waitcnt lgkmcnt(5)
  v_mfma_f32_32x32x16_bf16 v[8:23], a[36:39], v[236:239], v[8:23]
  ds_read_b128 a[60:63], v4 offset:41984
  v_exp_f32 v87, v87
  v_mul_f32 v88, v56, v64
  v_mul_f32 v89, v57, v65
  v_mul_f32 v90, v58, v66
  s_waitcnt lgkmcnt(5)
  v_mfma_f32_32x32x16_bf16 v[8:23], a[40:43], v[240:243], v[8:23]
  ds_read_b128 a[64:67], v4 offset:43008
  buffer_load_dwordx4 a[156:159], v4, s[4:7], s51 offen offset:2048
  v_mul_f32 v91, v59, v67
  v_fma_f32 v84, v84, v82, v82
  v_fma_f32 v85, v85, v82, v82
  v_fma_f32 v86, v86, v82, v82
  s_waitcnt lgkmcnt(5)
  v_mfma_f32_32x32x16_bf16 v[8:23], a[44:47], v[244:247], v[8:23]
  ds_read_b128 a[68:71], v4 offset:44032
  v_fma_f32 v87, v87, v82, v82
  v_rcp_f32 v84, v84
  v_rcp_f32 v85, v85
  s_waitcnt lgkmcnt(5)
  v_mfma_f32_32x32x16_bf16 v[8:23], a[48:51], v[248:251], v[8:23]
  ds_read_b128 a[24:27], v4 offset:45056
  buffer_load_dwordx4 a[160:163], v4, s[4:7], s51 offen offset:3072
  v_rcp_f32 v86, v86
  v_rcp_f32 v87, v87
  s_waitcnt lgkmcnt(5)
  v_mfma_f32_32x32x16_bf16 v[8:23], a[52:55], v[252:255], v[8:23]
  ds_read_b128 a[28:31], v4 offset:46080
  v_mul_f32 v88, v88, v84
  v_mul_f32 v89, v89, v85
  v_mul_f32 v90, v90, v86
  v_mul_f32 v91, v91, v87
  v_cvt_pk_bf16_f32 v92, v88, v89
  v_mfma_f32_32x32x16_bf16 v[8:23], a[16:19], v[76:79], v[8:23]
  s_waitcnt lgkmcnt(5)
  v_mfma_f32_32x32x16_bf16 v[24:39], a[56:59], v[96:99], 0
  ds_read_b128 a[32:35], v4 offset:47104
  s_add_u32 s51, s71, 8192
  buffer_load_dwordx4 a[164:167], v4, s[4:7], s51 offen offset:0
  v_cvt_pk_bf16_f32 v93, v90, v91
  v_mul_f32 v84, v60, v60
  v_mul_f32 v85, v61, v61
  s_waitcnt lgkmcnt(5)
  v_mfma_f32_32x32x16_bf16 v[24:39], a[60:63], v[100:103], v[24:39]
  ds_read_b128 a[36:39], v4 offset:48128
  v_mul_f32 v86, v62, v62
  v_mul_f32 v87, v63, v63
  v_fma_f32 v84, v84, v81, v80
  v_fma_f32 v85, v85, v81, v80
  v_fma_f32 v86, v86, v81, v80
  s_waitcnt lgkmcnt(5)
  v_mfma_f32_32x32x16_bf16 v[24:39], a[64:67], v[104:107], v[24:39]
  ds_read_b128 a[40:43], v4 offset:49152
  buffer_load_dwordx4 a[168:171], v4, s[4:7], s51 offen offset:1024
  v_fma_f32 v87, v87, v81, v80
  v_mul_f32 v84, v84, v60
  v_mul_f32 v85, v85, v61
  v_mul_f32 v86, v86, v62
  s_waitcnt lgkmcnt(5)
  v_mfma_f32_32x32x16_bf16 v[24:39], a[68:71], v[108:111], v[24:39]
  ds_read_b128 a[44:47], v4 offset:50176
  v_mul_f32 v87, v87, v63
  v_exp_f32 v84, v84
  v_exp_f32 v85, v85
  s_waitcnt lgkmcnt(5)
  v_mfma_f32_32x32x16_bf16 v[24:39], a[24:27], v[112:115], v[24:39]
  ds_read_b128 a[48:51], v4 offset:51200
  buffer_load_dwordx4 a[172:175], v4, s[4:7], s51 offen offset:2048
  v_exp_f32 v86, v86
  v_exp_f32 v87, v87
  s_waitcnt lgkmcnt(5)
  v_mfma_f32_32x32x16_bf16 v[24:39], a[28:31], v[116:119], v[24:39]
  ds_read_b128 a[52:55], v4 offset:52224
  v_mul_f32 v88, v60, v68
  v_mul_f32 v89, v61, v69
  v_mul_f32 v90, v62, v70
  v_mul_f32 v91, v63, v71
  v_fma_f32 v84, v84, v82, v82
  s_waitcnt lgkmcnt(5)
  v_mfma_f32_32x32x16_bf16 v[24:39], a[32:35], v[120:123], v[24:39]
  ds_read_b128 a[56:59], v4 offset:53248
  buffer_load_dwordx4 a[176:179], v4, s[4:7], s51 offen offset:3072
  v_fma_f32 v85, v85, v82, v82
  v_fma_f32 v86, v86, v82, v82
  v_fma_f32 v87, v87, v82, v82
  v_rcp_f32 v84, v84
  s_waitcnt lgkmcnt(5)
  v_mfma_f32_32x32x16_bf16 v[24:39], a[36:39], v[124:127], v[24:39]
  ds_read_b128 a[60:63], v4 offset:54272
  v_rcp_f32 v85, v85
  v_rcp_f32 v86, v86
  v_rcp_f32 v87, v87
  s_waitcnt lgkmcnt(5)
  v_mfma_f32_32x32x16_bf16 v[24:39], a[40:43], v[128:131], v[24:39]
  ds_read_b128 a[64:67], v4 offset:55296
  s_add_u32 s51, s71, 12288
  buffer_load_dwordx4 a[180:183], v4, s[4:7], s51 offen offset:0
  v_mul_f32 v88, v88, v84
  v_mul_f32 v89, v89, v85
  v_mul_f32 v90, v90, v86
  s_waitcnt lgkmcnt(5)
  v_mfma_f32_32x32x16_bf16 v[24:39], a[44:47], v[132:135], v[24:39]
  ds_read_b128 a[68:71], v4 offset:56320
  v_mul_f32 v91, v91, v87
  v_cvt_pk_bf16_f32 v94, v88, v89
  v_cvt_pk_bf16_f32 v95, v90, v91
  buffer_store_dwordx4 v[92:95], v4, s[4:7], s26 offen offset:3072 sc1
  v_mul_f32 v84, v8, v8
  s_waitcnt lgkmcnt(5)
  v_mfma_f32_32x32x16_bf16 v[24:39], a[48:51], v[136:139], v[24:39]
  s_waitcnt vmcnt(22)
  s_barrier
  s_cmp_lg_u32 s12, 0
  s_cbranch_scc1 E_f1
  v_mov_b32 v83, 1
  s_mov_b64 exec, 1
  buffer_store_dword v83, off, s[4:7], s65 sc1
  s_mov_b64 exec, -1
E_f1:
  ds_read_b128 a[24:27], v4 offset:57344
  buffer_load_dwordx4 a[184:187], v4, s[4:7], s51 offen offset:1024
  s_waitcnt lgkmcnt(5)
  v_mfma_f32_32x32x16_bf16 v[24:39], a[52:55], v[140:143], v[24:39]
  ds_read_b128 a[28:31], v4 offset:58368
  v_mul_f32 v85, v9, v9
  v_mul_f32 v86, v10, v10
  v_mul_f32 v87, v11, v11
  v_fma_f32 v84, v84, v81, v80
  v_fma_f32 v85, v85, v81, v80
  s_waitcnt lgkmcnt(5)
  v_mfma_f32_32x32x16_bf16 v[24:39], a[56:59], v[144:147], v[24:39]
  ds_read_b128 a[32:35], v4 offset:59392
  buffer_load_dwordx4 a[188:191], v4, s[4:7], s51 offen offset:2048
  v_fma_f32 v86, v86, v81, v80
  v_fma_f32 v87, v87, v81, v80
  v_mul_f32 v84, v84, v8
  v_mul_f32 v85, v85, v9
  s_waitcnt lgkmcnt(5)
  v_mfma_f32_32x32x16_bf16 v[24:39], a[60:63], v[148:151], v[24:39]
  ds_read_b128 a[36:39], v4 offset:60416
  v_mul_f32 v86, v86, v10
  v_mul_f32 v87, v87, v11
  v_exp_f32 v84, v84
  v_exp_f32 v85, v85
  s_waitcnt lgkmcnt(5)
  v_mfma_f32_32x32x16_bf16 v[24:39], a[64:67], v[152:155], v[24:39]
  ds_read_b128 a[40:43], v6 offset:0
  s_add_u32 s51, s72, 0
  buffer_load_dwordx4 a[192:195], v4, s[4:7], s51 offen offset:0
  v_exp_f32 v86, v86
  v_exp_f32 v87, v87
  s_waitcnt lgkmcnt(5)
  v_mfma_f32_32x32x16_bf16 v[24:39], a[68:71], v[156:159], v[24:39]
  ds_read_b128 a[44:47], v6 offset:1024
  v_mul_f32 v88, v8, v16
  v_mul_f32 v89, v9, v17
  v_mul_f32 v90, v10, v18
  v_mul_f32 v91, v11, v19
  v_fma_f32 v84, v84, v82, v82
  s_waitcnt lgkmcnt(5)
  v_mfma_f32_32x32x16_bf16 v[24:39], a[24:27], v[160:163], v[24:39]
  ds_read_b128 a[48:51], v6 offset:2048
  buffer_load_dwordx4 a[196:199], v4, s[4:7], s51 offen offset:1024
  v_fma_f32 v85, v85, v82, v82
  v_fma_f32 v86, v86, v82, v82
  v_fma_f32 v87, v87, v82, v82
  v_rcp_f32 v84, v84
  s_waitcnt lgkmcnt(5)
  v_mfma_f32_32x32x16_bf16 v[24:39], a[28:31], v[164:167], v[24:39]
  ds_read_b128 a[52:55], v6 offset:3072
  v_rcp_f32 v85, v85
  v_rcp_f32 v86, v86
  v_rcp_f32 v87, v87
  s_waitcnt lgkmcnt(5)
  v_mfma_f32_32x32x16_bf16 v[24:39], a[32:35], v[168:171], v[24:39]
  ds_read_b128 a[56:59], v6 offset:4096
  buffer_load_dwordx4 a[200:203], v4, s[4:7], s51 offen offset:2048
  v_mul_f32 v88, v88, v84
  v_mul_f32 v89, v89, v85
  v_mul_f32 v90, v90, v86
  v_mul_f32 v91, v91, v87
  s_waitcnt lgkmcnt(5)
  v_mfma_f32_32x32x16_bf16 v[24:39], a[36:39], v[172:175], v[24:39]
  ds_read_b128 a[60:63], v6 offset:5120
  v_cvt_pk_bf16_f32 v92, v88, v89
  v_cvt_pk_bf16_f32 v93, v90, v91
  v_mul_f32 v84, v12, v12
  v_mul_f32 v85, v13, v13
  v_mul_f32 v86, v14, v14
  s_waitcnt lgkmcnt(5)
  v_mfma_f32_32x32x16_bf16 v[24:39], a[40:43], v[176:179], v[24:39]
  ds_read_b128 a[64:67], v6 offset:6144
  buffer_load_dwordx4 a[204:207], v4, s[4:7], s51 offen offset:3072
  v_mul_f32 v87, v15, v15
  v_fma_f32 v84, v84, v81, v80
  v_fma_f32 v85, v85, v81, v80
  v_fma_f32 v86, v86, v81, v80
  s_waitcnt lgkmcnt(5)
  v_mfma_f32_32x32x16_bf16 v[24:39], a[44:47], v[180:183], v[24:39]
  ds_read_b128 a[68:71], v6 offset:7168
  v_fma_f32 v87, v87, v81, v80
  v_mul_f32 v84, v84, v12
  v_mul_f32 v85, v85, v13
  v_mul_f32 v86, v86, v14
  v_mul_f32 v87, v87, v15
  s_waitcnt lgkmcnt(5)
  v_mfma_f32_32x32x16_bf16 v[24:39], a[48:51], v[184:187], v[24:39]
  ds_read_b128 a[24:27], v6 offset:8192
  s_add_u32 s51, s72, 4096
  buffer_load_dwordx4 a[208:211], v4, s[4:7], s51 offen offset:0
  v_exp_f32 v84, v84
  v_exp_f32 v85, v85
  s_waitcnt lgkmcnt(5)
  v_mfma_f32_32x32x16_bf16 v[24:39], a[52:55], v[188:191], v[24:39]
  ds_read_b128 a[28:31], v6 offset:9216
  v_exp_f32 v86, v86
  v_exp_f32 v87, v87
  v_mul_f32 v88, v12, v20
  s_waitcnt lgkmcnt(5)
  v_mfma_f32_32x32x16_bf16 v[24:39], a[56:59], v[192:195], v[24:39]
  ds_read_b128 a[32:35], v6 offset:10240
  s_add_u32 s51, s73, 0
  buffer_load_dwordx4 a[212:215], v4, s[4:7], s51 offen offset:0
  v_mul_f32 v89, v13, v21
  v_mul_f32 v90, v14, v22
  v_mul_f32 v91, v15, v23
  s_waitcnt lgkmcnt(5)
  v_mfma_f32_32x32x16_bf16 v[24:39], a[60:63], v[196:199], v[24:39]
  ds_read_b128 a[36:39], v6 offset:11264
  v_fma_f32 v84, v84, v82, v82
  v_fma_f32 v85, v85, v82, v82
  v_fma_f32 v86, v86, v82, v82
  v_fma_f32 v87, v87, v82, v82
  v_rcp_f32 v84, v84
  s_waitcnt lgkmcnt(5)
  v_mfma_f32_32x32x16_bf16 v[24:39], a[64:67], v[200:203], v[24:39]
  ds_read_b128 a[40:43], v6 offset:12288
  buffer_load_dwordx4 a[216:219], v4, s[4:7], s51 offen offset:1024
  v_rcp_f32 v85, v85
  v_rcp_f32 v86, v86
  s_waitcnt lgkmcnt(5)
  v_mfma_f32_32x32x16_bf16 v[24:39], a[68:71], v[204:207], v[24:39]
  ds_read_b128 a[44:47], v6 offset:13312
  v_rcp_f32 v87, v87
  v_mul_f32 v88, v88, v84
  v_mul_f32 v89, v89, v85
  v_mul_f32 v90, v90, v86
  s_waitcnt lgkmcnt(5)
  v_mfma_f32_32x32x16_bf16 v[24:39], a[24:27], v[208:211], v[24:39]
  ds_read_b128 a[48:51], v6 offset:14336
  buffer_load_dwordx4 a[220:223], v4, s[4:7], s51 offen offset:2048
  v_mul_f32 v91, v91, v87
  v_cvt_pk_bf16_f32 v94, v88, v89
  v_cvt_pk_bf16_f32 v95, v90, v91
  buffer_store_dwordx4 v[92:95], v4, s[4:7], s27 offen offset:0 sc1
  s_waitcnt lgkmcnt(5)
  v_mfma_f32_32x32x16_bf16 v[24:39], a[28:31], v[212:215], v[24:39]
  ds_read_b128 a[52:55], v6 offset:15360
  s_waitcnt lgkmcnt(5)
  v_mfma_f32_32x32x16_bf16 v[24:39], a[32:35], v[216:219], v[24:39]
  ds_read_b128 a[56:59], v6 offset:16384
  buffer_load_dwordx4 a[224:227], v4, s[4:7], s51 offen offset:3072
  s_waitcnt lgkmcnt(5)
  v_mfma_f32_32x32x16_bf16 v[24:39], a[36:39], v[220:223], v[24:39]
  ds_read_b128 a[60:63], v6 offset:17408
  s_waitcnt lgkmcnt(5)
  v_mfma_f32_32x32x16_bf16 v[24:39], a[40:43], v[224:227], v[24:39]
  buffer_load_dwordx4 v[160:163], off, s[4:7], s64 sc1
  ds_read_b128 a[64:67], v6 offset:18432
  s_waitcnt lgkmcnt(5)
  v_mfma_f32_32x32x16_bf16 v[24:39], a[44:47], v[228:231], v[24:39]
  ds_read_b128 a[68:71], v6 offset:19456
  s_waitcnt lgkmcnt(5)
  v_mfma_f32_32x32x16_bf16 v[24:39], a[48:51], v[232:235], v[24:39]
  s_waitcnt lgkmcnt(4)
  v_mfma_f32_32x32x16_bf16 v[24:39], a[52:55], v[236:239], v[24:39]
  s_waitcnt lgkmcnt(3)
  v_mfma_f32_32x32x16_bf16 v[24:39], a[56:59], v[240:243], v[24:39]
  s_waitcnt lgkmcnt(2)
  v_mfma_f32_32x32x16_bf16 v[24:39], a[60:63], v[244:247], v[24:39]
  s_waitcnt lgkmcnt(1)
  v_mfma_f32_32x32x16_bf16 v[24:39], a[64:67], v[248:251], v[24:39]
  s_waitcnt lgkmcnt(0)
  v_mfma_f32_32x32x16_bf16 v[24:39], a[68:71], v[252:255], v[24:39]
  v_mfma_f32_32x32x16_bf16 v[24:39], a[20:23], v[76:79], v[24:39]
  v_mov_b32 v72, v81
  v_mov_b32 v74, v82
  s_nop 9
  v_pk_mul_f32 v[56:57], v[24:25], v[24:25]
  v_pk_mul_f32 v[58:59], v[26:27], v[26:27]
  v_pk_mul_f32 v[60:61], v[28:29], v[28:29]
  v_pk_mul_f32 v[62:63], v[30:31], v[30:31]
  v_pk_fma_f32 v[56:57], v[56:57], v[72:73], v[80:81] op_sel_hi:[1,0,0]
  v_pk_fma_f32 v[58:59], v[58:59], v[72:73], v[80:81] op_sel_hi:[1,0,0]
  v_pk_fma_f32 v[60:61], v[60:61], v[72:73], v[80:81] op_sel_hi:[1,0,0]
  v_pk_fma_f32 v[62:63], v[62:63], v[72:73], v[80:81] op_sel_hi:[1,0,0]
  v_pk_mul_f32 v[56:57], v[56:57], v[24:25]
  v_pk_mul_f32 v[58:59], v[58:59], v[26:27]
  v_pk_mul_f32 v[60:61], v[60:61], v[28:29]
  v_pk_mul_f32 v[62:63], v[62:63], v[30:31]
  v_exp_f32 v56, v56
  v_exp_f32 v57, v57
  v_exp_f32 v58, v58
  v_exp_f32 v59, v59
  v_exp_f32 v60, v60
  v_exp_f32 v61, v61
  v_exp_f32 v62, v62
  v_exp_f32 v63, v63
  v_pk_mul_f32 v[64:65], v[24:25], v[32:33]
  v_pk_mul_f32 v[66:67], v[26:27], v[34:35]
  v_pk_mul_f32 v[68:69], v[28:29], v[36:37]
  v_pk_mul_f32 v[70:71], v[30:31], v[38:39]
  v_pk_fma_f32 v[56:57], v[56:57], v[74:75], v[74:75] op_sel_hi:[1,0,0]
  v_pk_fma_f32 v[58:59], v[58:59], v[74:75], v[74:75] op_sel_hi:[1,0,0]
  v_pk_fma_f32 v[60:61], v[60:61], v[74:75], v[74:75] op_sel_hi:[1,0,0]
  v_pk_fma_f32 v[62:63], v[62:63], v[74:75], v[74:75] op_sel_hi:[1,0,0]
  v_rcp_f32 v56, v56
  v_rcp_f32 v57, v57
  v_rcp_f32 v58, v58
  v_rcp_f32 v59, v59
  v_rcp_f32 v60, v60
  v_rcp_f32 v61, v61
  v_rcp_f32 v62, v62
  v_rcp_f32 v63, v63
  v_pk_mul_f32 v[64:65], v[64:65], v[56:57]
  v_pk_mul_f32 v[66:67], v[66:67], v[58:59]
  v_pk_mul_f32 v[68:69], v[68:69], v[60:61]
  v_pk_mul_f32 v[70:71], v[70:71], v[62:63]
  v_cvt_pk_bf16_f32 v56, v64, v65
  v_cvt_pk_bf16_f32 v57, v66, v67
  v_cvt_pk_bf16_f32 v58, v68, v69
  v_cvt_pk_bf16_f32 v59, v70, v71
  buffer_store_dwordx4 v[56:59], v4, s[4:7], s27 offen offset:1024 sc1
  s_waitcnt vmcnt(1)
  v_and_b32 v160, v160, v161
  v_and_b32 v162, v162, v163
  v_and_b32 v160, v160, v162
  s_nop 0
  v_readfirstlane_b32 s66, v160
  s_bitcmp0_b32 s66, 0
  s_cbranch_scc1 E_p1_retry
E_p1_ok:
  s_add_u32 s51, s73, 4096
  buffer_load_dwordx4 a[228:231], v4, s[4:7], s51 offen offset:0
  s_add_u32 s25, s57, s74
  buffer_load_dwordx4 v[96:99], v5, s[4:7], s25 offen offset:0 sc1
  s_add_u32 s25, s57, s75
  buffer_load_dwordx4 v[100:103], v5, s[4:7], s25 offen offset:0 sc1
  s_add_u32 s25, s57, s76
  buffer_load_dwordx4 v[104:107], v5, s[4:7], s25 offen offset:0 sc1
  s_add_u32 s25, s57, s77
  buffer_load_dwordx4 v[108:111], v5, s[4:7], s25 offen offset:0 sc1
  s_add_u32 s25, s58, s74
  buffer_load_dwordx4 v[112:115], v5, s[4:7], s25 offen offset:0 sc1
  s_add_u32 s25, s58, s75
  buffer_load_dwordx4 v[116:119], v5, s[4:7], s25 offen offset:0 sc1
  s_add_u32 s25, s58, s76
  buffer_load_dwordx4 v[120:123], v5, s[4:7], s25 offen offset:0 sc1
  v_add_u32 v91, s32, v4
  v_add_u32 v88, s33, v4
  v_add_u32 v89, s34, v4
  v_add_u32 v90, s35, v4
  v_and_b32 v2, 15, v0
  v_mul_u32_u24 v6, 1280, v2
  v_lshl_add_u32 v7, v3, 3, v6
  v_lshl_add_u32 v6, v3, 4, v6
  v_accvgpr_read_b32 v8, a0
  v_accvgpr_read_b32 v9, a1
  v_accvgpr_read_b32 v10, a2
  v_accvgpr_read_b32 v11, a3
  v_accvgpr_read_b32 v12, a4
  v_accvgpr_read_b32 v13, a5
  v_accvgpr_read_b32 v14, a6
  v_accvgpr_read_b32 v15, a7
  v_accvgpr_read_b32 v16, a8
  v_accvgpr_read_b32 v17, a9
  v_lshlrev_b32 v68, 16, v8
  v_and_b32 v69, 0xffff0000, v8
  v_lshlrev_b32 v70, 16, v9
  v_and_b32 v71, 0xffff0000, v9
  v_lshlrev_b32 v72, 16, v10
  v_and_b32 v73, 0xffff0000, v10
  v_lshlrev_b32 v74, 16, v11
  v_and_b32 v75, 0xffff0000, v11
  v_lshlrev_b32 v76, 16, v12
  v_and_b32 v77, 0xffff0000, v12
  v_lshlrev_b32 v78, 16, v13
  v_and_b32 v79, 0xffff0000, v13
  v_lshlrev_b32 v80, 16, v14
  v_and_b32 v81, 0xffff0000, v14
  v_lshlrev_b32 v82, 16, v15
  v_and_b32 v83, 0xffff0000, v15
  v_lshlrev_b32 v84, 16, v16
  v_and_b32 v85, 0xffff0000, v16
  v_lshlrev_b32 v86, 16, v17
  v_and_b32 v87, 0xffff0000, v17
  s_waitcnt vmcnt(8)
  s_barrier
  s_cmp_lg_u32 s12, 0
  s_cbranch_scc1 E_f2
  v_mov_b32 v2, 3
  s_mov_b64 exec, 1
  buffer_store_dword v2, off, s[4:7], s65 sc1
  s_mov_b64 exec, -1
E_f2:
  s_add_u32 s25, s58, s77
  buffer_load_dwordx4 v[124:127], v5, s[4:7], s25 offen offset:0 sc1
  s_add_u32 s25, s59, s74
  buffer_load_dwordx4 v[128:131], v5, s[4:7], s25 offen offset:0 sc1
  s_add_u32 s25, s59, s75
  buffer_load_dwordx4 v[132:135], v5, s[4:7], s25 offen offset:0 sc1
  s_add_u32 s25, s59, s76
  buffer_load_dwordx4 v[136:139], v5, s[4:7], s25 offen offset:0 sc1
  s_waitcnt vmcnt(10)
  v_mfma_f32_16x16x32_bf16 v[8:11], a[72:75], v[96:99], 0
  v_mfma_f32_16x16x32_bf16 v[12:15], a[76:79], v[96:99], 0
  v_mfma_f32_16x16x32_bf16 v[16:19], a[80:83], v[96:99], 0
  v_mfma_f32_16x16x32_bf16 v[20:23], a[84:87], v[96:99], 0
  s_add_u32 s25, s59, s77
  buffer_load_dwordx4 v[140:143], v5, s[4:7], s25 offen offset:0 sc1
  v_mfma_f32_16x16x32_bf16 v[24:27], a[88:91], v[96:99], 0
  s_waitcnt vmcnt(10)
  v_mfma_f32_16x16x32_bf16 v[8:11], a[132:135], v[100:103], v[8:11]
  v_mfma_f32_16x16x32_bf16 v[12:15], a[136:139], v[100:103], v[12:15]
  v_mfma_f32_16x16x32_bf16 v[16:19], a[140:143], v[100:103], v[16:19]
  s_add_u32 s25, s56, s74
  buffer_load_dwordx4 v[144:147], v5, s[4:7], s25 offen offset:0 sc1
  v_mfma_f32_16x16x32_bf16 v[20:23], a[144:147], v[100:103], v[20:23]
  v_mfma_f32_16x16x32_bf16 v[24:27], a[148:151], v[100:103], v[24:27]
  s_waitcnt vmcnt(10)
  v_mfma_f32_16x16x32_bf16 v[8:11], a[192:195], v[104:107], v[8:11]
  v_mfma_f32_16x16x32_bf16 v[12:15], a[196:199], v[104:107], v[12:15]
  s_add_u32 s25, s56, s75
  buffer_load_dwordx4 v[148:151], v5, s[4:7], s25 offen offset:0 sc1
  v_mfma_f32_16x16x32_bf16 v[16:19], a[200:203], v[104:107], v[16:19]
  v_mfma_f32_16x16x32_bf16 v[20:23], a[204:207], v[104:107], v[20:23]
  v_mfma_f32_16x16x32_bf16 v[24:27], a[208:211], v[104:107], v[24:27]
  s_waitcnt vmcnt(10)
  v_mfma_f32_16x16x32_bf16 v[8:11], a[212:215], v[108:111], v[8:11]
  s_add_u32 s25, s56, s76
  buffer_load_dwordx4 v[152:155], v5, s[4:7], s25 offen offset:0 sc1
  v_mfma_f32_16x16x32_bf16 v[12:15], a[216:219], v[108:111], v[12:15]
  v_mfma_f32_16x16x32_bf16 v[16:19], a[220:223], v[108:111], v[16:19]
  v_mfma_f32_16x16x32_bf16 v[20:23], a[224:227], v[108:111], v[20:23]
  v_mfma_f32_16x16x32_bf16 v[24:27], a[228:231], v[108:111], v[24:27]
  s_add_u32 s25, s56, s77
  buffer_load_dwordx4 v[156:159], v5, s[4:7], s25 offen offset:0 sc1
  s_waitcnt vmcnt(11)
  v_mfma_f32_16x16x32_bf16 v[28:31], a[72:75], v[112:115], 0
  v_mfma_f32_16x16x32_bf16 v[32:35], a[76:79], v[112:115], 0
  v_mfma_f32_16x16x32_bf16 v[36:39], a[80:83], v[112:115], 0
  v_mfma_f32_16x16x32_bf16 v[40:43], a[84:87], v[112:115], 0
  s_add_u32 s51, s72, 5120
  buffer_load_dwordx4 a[232:235], v4, s[4:7], s51 offen offset:0
  v_mfma_f32_16x16x32_bf16 v[44:47], a[88:91], v[112:115], 0
  s_waitcnt vmcnt(11)
  v_mfma_f32_16x16x32_bf16 v[28:31], a[132:135], v[116:119], v[28:31]
  v_mfma_f32_16x16x32_bf16 v[32:35], a[136:139], v[116:119], v[32:35]
  v_mfma_f32_16x16x32_bf16 v[36:39], a[140:143], v[116:119], v[36:39]
  buffer_load_dwordx4 a[236:239], v4, s[4:7], s51 offen offset:1024
  v_mfma_f32_16x16x32_bf16 v[40:43], a[144:147], v[116:119], v[40:43]
  v_mfma_f32_16x16x32_bf16 v[44:47], a[148:151], v[116:119], v[44:47]
  s_waitcnt vmcnt(11)
  v_mfma_f32_16x16x32_bf16 v[28:31], a[192:195], v[120:123], v[28:31]
  v_mfma_f32_16x16x32_bf16 v[32:35], a[196:199], v[120:123], v[32:35]
  buffer_load_dwordx4 a[240:243], v4, s[4:7], s51 offen offset:2048
  v_mfma_f32_16x16x32_bf16 v[36:39], a[200:203], v[120:123], v[36:39]
  v_mfma_f32_16x16x32_bf16 v[40:43], a[204:207], v[120:123], v[40:43]
  v_mfma_f32_16x16x32_bf16 v[44:47], a[208:211], v[120:123], v[44:47]
  s_waitcnt vmcnt(11)
  v_mfma_f32_16x16x32_bf16 v[28:31], a[212:215], v[124:127], v[28:31]
  buffer_load_dwordx4 a[244:247], v4, s[4:7], s51 offen offset:3072
  v_mfma_f32_16x16x32_bf16 v[32:35], a[216:219], v[124:127], v[32:35]
  v_mfma_f32_16x16x32_bf16 v[36:39], a[220:223], v[124:127], v[36:39]
  v_mfma_f32_16x16x32_bf16 v[40:43], a[224:227], v[124:127], v[40:43]
  v_mfma_f32_16x16x32_bf16 v[44:47], a[228:231], v[124:127], v[44:47]
  s_add_u32 s51, s72, 9216
  buffer_load_dwordx4 a[248:251], v4, s[4:7], s51 offen offset:0
  s_waitcnt vmcnt(12)
  v_mfma_f32_16x16x32_bf16 v[48:51], a[72:75], v[128:131], 0
  v_mfma_f32_16x16x32_bf16 v[52:55], a[76:79], v[128:131], 0
  v_mfma_f32_16x16x32_bf16 v[56:59], a[80:83], v[128:131], 0
  v_mfma_f32_16x16x32_bf16 v[60:63], a[84:87], v[128:131], 0
  s_add_u32 s51, s73, 5120
  buffer_load_dwordx4 a[252:255], v4, s[4:7], s51 offen offset:0
  v_mfma_f32_16x16x32_bf16 v[64:67], a[88:91], v[128:131], 0
  s_waitcnt vmcnt(12)
  v_mfma_f32_16x16x32_bf16 v[48:51], a[132:135], v[132:135], v[48:51]
  v_mfma_f32_16x16x32_bf16 v[52:55], a[136:139], v[132:135], v[52:55]
  v_mfma_f32_16x16x32_bf16 v[56:59], a[140:143], v[132:135], v[56:59]
  buffer_load_dwordx4 a[16:19], v4, s[4:7], s51 offen offset:1024
  v_mfma_f32_16x16x32_bf16 v[60:63], a[144:147], v[132:135], v[60:63]
  v_mfma_f32_16x16x32_bf16 v[64:67], a[148:151], v[132:135], v[64:67]
  s_waitcnt vmcnt(12)
  v_mfma_f32_16x16x32_bf16 v[48:51], a[192:195], v[136:139], v[48:51]
  v_mfma_f32_16x16x32_bf16 v[52:55], a[196:199], v[136:139], v[52:55]
  buffer_load_dwordx4 a[20:23], v4, s[4:7], s51 offen offset:2048
  v_mfma_f32_16x16x32_bf16 v[56:59], a[200:203], v[136:139], v[56:59]
  v_mfma_f32_16x16x32_bf16 v[60:63], a[204:207], v[136:139], v[60:63]
  v_mfma_f32_16x16x32_bf16 v[64:67], a[208:211], v[136:139], v[64:67]
  s_waitcnt vmcnt(12)
  v_mfma_f32_16x16x32_bf16 v[48:51], a[212:215], v[140:143], v[48:51]
  buffer_load_dwordx4 v[92:95], off, s[4:7], s64 sc1
  v_mfma_f32_16x16x32_bf16 v[52:55], a[216:219], v[140:143], v[52:55]
  v_mfma_f32_16x16x32_bf16 v[56:59], a[220:223], v[140:143], v[56:59]
  v_mfma_f32_16x16x32_bf16 v[60:63], a[224:227], v[140:143], v[60:63]
  v_mfma_f32_16x16x32_bf16 v[64:67], a[228:231], v[140:143], v[64:67]
  buffer_load_dwordx4 a[24:27], v4, s[4:7], s51 offen offset:3072
  s_waitcnt vmcnt(13)
  v_mfma_f32_16x16x32_bf16 v[68:71], a[72:75], v[144:147], v[68:71]
  v_mfma_f32_16x16x32_bf16 v[72:75], a[76:79], v[144:147], v[72:75]
  v_mfma_f32_16x16x32_bf16 v[76:79], a[80:83], v[144:147], v[76:79]
  v_mfma_f32_16x16x32_bf16 v[80:83], a[84:87], v[144:147], v[80:83]
  s_add_u32 s51, s73, 9216
  buffer_load_dwordx4 a[28:31], v4, s[4:7], s51 offen offset:0
  v_mfma_f32_16x16x32_bf16 v[84:87], a[88:91], v[144:147], v[84:87]
  s_waitcnt vmcnt(13)
  v_mfma_f32_16x16x32_bf16 v[68:71], a[132:135], v[148:151], v[68:71]
  v_mfma_f32_16x16x32_bf16 v[72:75], a[136:139], v[148:151], v[72:75]
  v_mfma_f32_16x16x32_bf16 v[76:79], a[140:143], v[148:151], v[76:79]
  s_add_u32 s51, s72, 10240
  buffer_load_dwordx4 a[32:35], v4, s[4:7], s51 offen offset:0
  v_mfma_f32_16x16x32_bf16 v[80:83], a[144:147], v[148:151], v[80:83]
  v_mfma_f32_16x16x32_bf16 v[84:87], a[148:151], v[148:151], v[84:87]
  s_waitcnt vmcnt(13)
  v_mfma_f32_16x16x32_bf16 v[68:71], a[192:195], v[152:155], v[68:71]
  v_mfma_f32_16x16x32_bf16 v[72:75], a[196:199], v[152:155], v[72:75]
  buffer_load_dwordx4 a[36:39], v4, s[4:7], s51 offen offset:1024
  v_mfma_f32_16x16x32_bf16 v[76:79], a[200:203], v[152:155], v[76:79]
  v_mfma_f32_16x16x32_bf16 v[80:83], a[204:207], v[152:155], v[80:83]
  v_mfma_f32_16x16x32_bf16 v[84:87], a[208:211], v[152:155], v[84:87]
  s_waitcnt vmcnt(13)
  v_mfma_f32_16x16x32_bf16 v[68:71], a[212:215], v[156:159], v[68:71]
  buffer_load_dwordx4 a[40:43], v4, s[4:7], s51 offen offset:2048
  v_mfma_f32_16x16x32_bf16 v[72:75], a[216:219], v[156:159], v[72:75]
  v_mfma_f32_16x16x32_bf16 v[76:79], a[220:223], v[156:159], v[76:79]
  v_mfma_f32_16x16x32_bf16 v[80:83], a[224:227], v[156:159], v[80:83]
  v_mfma_f32_16x16x32_bf16 v[84:87], a[228:231], v[156:159], v[84:87]
  buffer_load_dwordx4 a[44:47], v4, s[4:7], s51 offen offset:3072
  s_add_u32 s51, s72, 14336
  buffer_load_dwordx4 a[48:51], v4, s[4:7], s51 offen offset:0
  s_add_u32 s51, s73, 10240
  buffer_load_dwordx4 a[52:55], v4, s[4:7], s51 offen offset:0
  buffer_load_dwordx4 a[56:59], v4, s[4:7], s51 offen offset:1024
  buffer_load_dwordx4 a[60:63], v4, s[4:7], s51 offen offset:2048
  buffer_load_dwordx4 a[64:67], v4, s[4:7], s51 offen offset:3072
  s_add_u32 s51, s73, 14336
  buffer_load_dwordx4 a[68:71], v4, s[4:7], s51 offen offset:0
  s_waitcnt vmcnt(12)
  v_and_b32 v92, v92, v93
  v_and_b32 v94, v94, v95
  v_and_b32 v92, v92, v94
  s_nop 0
  v_readfirstlane_b32 s66, v92
  s_bitcmp0_b32 s66, 1
  s_cbranch_scc1 E_p2_retry
E_p2_ok:
  s_add_u32 s25, s57, s74
  buffer_load_dwordx4 v[160:163], v5, s[4:7], s25 offen offset:2048 sc1
  buffer_load_dwordx4 v[164:167], v1, s[4:7], s25 offen offset:0 sc1
  s_add_u32 s25, s57, s75
  buffer_load_dwordx4 v[168:171], v5, s[4:7], s25 offen offset:2048 sc1
  buffer_load_dwordx4 v[172:175], v1, s[4:7], s25 offen offset:0 sc1
  s_add_u32 s25, s57, s76
  buffer_load_dwordx4 v[176:179], v5, s[4:7], s25 offen offset:2048 sc1
  buffer_load_dwordx4 v[180:183], v1, s[4:7], s25 offen offset:0 sc1
  s_add_u32 s25, s57, s77
  buffer_load_dwordx4 v[184:187], v5, s[4:7], s25 offen offset:2048 sc1
  buffer_load_dwordx4 v[188:191], v1, s[4:7], s25 offen offset:0 sc1
  s_add_u32 s25, s58, s74
  buffer_load_dwordx4 v[192:195], v5, s[4:7], s25 offen offset:2048 sc1
  buffer_load_dwordx4 v[196:199], v1, s[4:7], s25 offen offset:0 sc1
  s_add_u32 s25, s58, s75
  buffer_load_dwordx4 v[200:203], v5, s[4:7], s25 offen offset:2048 sc1
  buffer_load_dwordx4 v[204:207], v1, s[4:7], s25 offen offset:0 sc1
  s_waitcnt vmcnt(11)
  v_mfma_f32_16x16x32_bf16 v[8:11], a[92:95], v[160:163], v[8:11]
  v_mfma_f32_16x16x32_bf16 v[12:15], a[96:99], v[160:163], v[12:15]
  v_mfma_f32_16x16x32_bf16 v[16:19], a[100:103], v[160:163], v[16:19]
  v_mfma_f32_16x16x32_bf16 v[20:23], a[104:107], v[160:163], v[20:23]
  v_mfma_f32_16x16x32_bf16 v[24:27], a[108:111], v[160:163], v[24:27]
  s_add_u32 s25, s58, s76
  buffer_load_dwordx4 v[208:211], v5, s[4:7], s25 offen offset:2048 sc1
  s_waitcnt vmcnt(11)
  v_mfma_f32_16x16x32_bf16 v[8:11], a[112:115], v[164:167], v[8:11]
  v_mfma_f32_16x16x32_bf16 v[12:15], a[116:119], v[164:167], v[12:15]
  v_mfma_f32_16x16x32_bf16 v[16:19], a[120:123], v[164:167], v[16:19]
  v_mfma_f32_16x16x32_bf16 v[20:23], a[124:127], v[164:167], v[20:23]
  v_mfma_f32_16x16x32_bf16 v[24:27], a[128:131], v[164:167], v[24:27]
  buffer_load_dwordx4 v[212:215], v1, s[4:7], s25 offen offset:0 sc1
  s_waitcnt vmcnt(11)
  v_mfma_f32_16x16x32_bf16 v[8:11], a[152:155], v[168:171], v[8:11]
  v_mfma_f32_16x16x32_bf16 v[12:15], a[156:159], v[168:171], v[12:15]
  v_mfma_f32_16x16x32_bf16 v[16:19], a[160:163], v[168:171], v[16:19]
  v_mfma_f32_16x16x32_bf16 v[20:23], a[164:167], v[168:171], v[20:23]
  v_mfma_f32_16x16x32_bf16 v[24:27], a[168:171], v[168:171], v[24:27]
  s_add_u32 s25, s58, s77
  buffer_load_dwordx4 v[216:219], v5, s[4:7], s25 offen offset:2048 sc1
  s_waitcnt vmcnt(11)
  v_mfma_f32_16x16x32_bf16 v[8:11], a[172:175], v[172:175], v[8:11]
  v_mfma_f32_16x16x32_bf16 v[12:15], a[176:179], v[172:175], v[12:15]
  v_mfma_f32_16x16x32_bf16 v[16:19], a[180:183], v[172:175], v[16:19]
  v_mfma_f32_16x16x32_bf16 v[20:23], a[184:187], v[172:175], v[20:23]
  v_mfma_f32_16x16x32_bf16 v[24:27], a[188:191], v[172:175], v[24:27]
  buffer_load_dwordx4 v[220:223], v1, s[4:7], s25 offen offset:0 sc1
  s_waitcnt vmcnt(11)
  v_mfma_f32_16x16x32_bf16 v[8:11], a[232:235], v[176:179], v[8:11]
  v_mfma_f32_16x16x32_bf16 v[12:15], a[236:239], v[176:179], v[12:15]
  v_mfma_f32_16x16x32_bf16 v[16:19], a[240:243], v[176:179], v[16:19]
  v_mfma_f32_16x16x32_bf16 v[20:23], a[244:247], v[176:179], v[20:23]
  v_mfma_f32_16x16x32_bf16 v[24:27], a[248:251], v[176:179], v[24:27]
  s_add_u32 s25, s59, s74
  buffer_load_dwordx4 v[224:227], v5, s[4:7], s25 offen offset:2048 sc1
  s_waitcnt vmcnt(11)
  v_mfma_f32_16x16x32_bf16 v[8:11], a[32:35], v[180:183], v[8:11]
  v_mfma_f32_16x16x32_bf16 v[12:15], a[36:39], v[180:183], v[12:15]
  v_mfma_f32_16x16x32_bf16 v[16:19], a[40:43], v[180:183], v[16:19]
  v_mfma_f32_16x16x32_bf16 v[20:23], a[44:47], v[180:183], v[20:23]
  v_mfma_f32_16x16x32_bf16 v[24:27], a[48:51], v[180:183], v[24:27]
  buffer_load_dwordx4 v[228:231], v1, s[4:7], s25 offen offset:0 sc1
  s_waitcnt vmcnt(11)
  v_mfma_f32_16x16x32_bf16 v[8:11], a[252:255], v[184:187], v[8:11]
  v_mfma_f32_16x16x32_bf16 v[12:15], a[16:19], v[184:187], v[12:15]
  v_mfma_f32_16x16x32_bf16 v[16:19], a[20:23], v[184:187], v[16:19]
  v_mfma_f32_16x16x32_bf16 v[20:23], a[24:27], v[184:187], v[20:23]
  v_mfma_f32_16x16x32_bf16 v[24:27], a[28:31], v[184:187], v[24:27]
  s_add_u32 s25, s59, s75
  buffer_load_dwordx4 v[232:235], v5, s[4:7], s25 offen offset:2048 sc1
  s_waitcnt vmcnt(11)
  v_mfma_f32_16x16x32_bf16 v[8:11], a[52:55], v[188:191], v[8:11]
  v_mfma_f32_16x16x32_bf16 v[12:15], a[56:59], v[188:191], v[12:15]
  v_mfma_f32_16x16x32_bf16 v[16:19], a[60:63], v[188:191], v[16:19]
  v_mfma_f32_16x16x32_bf16 v[20:23], a[64:67], v[188:191], v[20:23]
  v_mfma_f32_16x16x32_bf16 v[24:27], a[68:71], v[188:191], v[24:27]
  buffer_load_dwordx4 v[236:239], v1, s[4:7], s25 offen offset:0 sc1
  s_waitcnt vmcnt(11)
  v_mfma_f32_16x16x32_bf16 v[28:31], a[92:95], v[192:195], v[28:31]
  v_mfma_f32_16x16x32_bf16 v[32:35], a[96:99], v[192:195], v[32:35]
  v_mfma_f32_16x16x32_bf16 v[36:39], a[100:103], v[192:195], v[36:39]
  ds_write_b128 v88, v[8:11] offset:0
  ds_write_b128 v88, v[12:15] offset:1024
  v_mfma_f32_16x16x32_bf16 v[40:43], a[104:107], v[192:195], v[40:43]
  ds_write_b128 v88, v[16:19] offset:2048
  ds_write_b128 v88, v[20:23] offset:3072
  v_mfma_f32_16x16x32_bf16 v[44:47], a[108:111], v[192:195], v[44:47]
  s_add_u32 s25, s59, s76
  buffer_load_dwordx4 v[240:243], v5, s[4:7], s25 offen offset:2048 sc1
  s_waitcnt vmcnt(11)
  v_mfma_f32_16x16x32_bf16 v[28:31], a[112:115], v[196:199], v[28:31]
  ds_write_b128 v88, v[24:27] offset:4096
  v_mfma_f32_16x16x32_bf16 v[32:35], a[116:119], v[196:199], v[32:35]
  v_mfma_f32_16x16x32_bf16 v[36:39], a[120:123], v[196:199], v[36:39]
  v_mfma_f32_16x16x32_bf16 v[40:43], a[124:127], v[196:199], v[40:43]
  v_mfma_f32_16x16x32_bf16 v[44:47], a[128:131], v[196:199], v[44:47]
  buffer_load_dwordx4 v[244:247], v1, s[4:7], s25 offen offset:0 sc1
  s_waitcnt vmcnt(11)
  v_mfma_f32_16x16x32_bf16 v[28:31], a[152:155], v[200:203], v[28:31]
  v_mfma_f32_16x16x32_bf16 v[32:35], a[156:159], v[200:203], v[32:35]
  v_mfma_f32_16x16x32_bf16 v[36:39], a[160:163], v[200:203], v[36:39]
  v_mfma_f32_16x16x32_bf16 v[40:43], a[164:167], v[200:203], v[40:43]
  v_mfma_f32_16x16x32_bf16 v[44:47], a[168:171], v[200:203], v[44:47]
  s_add_u32 s25, s59, s77
  buffer_load_dwordx4 v[248:251], v5, s[4:7], s25 offen offset:2048 sc1
  s_waitcnt vmcnt(11)
  v_mfma_f32_16x16x32_bf16 v[28:31], a[172:175], v[204:207], v[28:31]
  v_mfma_f32_16x16x32_bf16 v[32:35], a[176:179], v[204:207], v[32:35]
  v_mfma_f32_16x16x32_bf16 v[36:39], a[180:183], v[204:207], v[36:39]
  v_mfma_f32_16x16x32_bf16 v[40:43], a[184:187], v[204:207], v[40:43]
  v_mfma_f32_16x16x32_bf16 v[44:47], a[188:191], v[204:207], v[44:47]
  buffer_load_dwordx4 v[252:255], v1, s[4:7], s25 offen offset:0 sc1
  s_waitcnt vmcnt(11)
  v_mfma_f32_16x16x32_bf16 v[28:31], a[232:235], v[208:211], v[28:31]
  v_mfma_f32_16x16x32_bf16 v[32:35], a[236:239], v[208:211], v[32:35]
  v_mfma_f32_16x16x32_bf16 v[36:39], a[240:243], v[208:211], v[36:39]
  v_mfma_f32_16x16x32_bf16 v[40:43], a[244:247], v[208:211], v[40:43]
  v_mfma_f32_16x16x32_bf16 v[44:47], a[248:251], v[208:211], v[44:47]
  s_add_u32 s25, s56, s74
  buffer_load_dwordx4 v[96:99], v5, s[4:7], s25 offen offset:2048 sc1
  s_waitcnt vmcnt(11)
  v_mfma_f32_16x16x32_bf16 v[28:31], a[32:35], v[212:215], v[28:31]
  v_mfma_f32_16x16x32_bf16 v[32:35], a[36:39], v[212:215], v[32:35]
  v_mfma_f32_16x16x32_bf16 v[36:39], a[40:43], v[212:215], v[36:39]
  v_mfma_f32_16x16x32_bf16 v[40:43], a[44:47], v[212:215], v[40:43]
  v_mfma_f32_16x16x32_bf16 v[44:47], a[48:51], v[212:215], v[44:47]
  buffer_load_dwordx4 v[100:103], v1, s[4:7], s25 offen offset:0 sc1
  s_waitcnt vmcnt(11)
  v_mfma_f32_16x16x32_bf16 v[28:31], a[252:255], v[216:219], v[28:31]
  v_mfma_f32_16x16x32_bf16 v[32:35], a[16:19], v[216:219], v[32:35]
  v_mfma_f32_16x16x32_bf16 v[36:39], a[20:23], v[216:219], v[36:39]
  v_mfma_f32_16x16x32_bf16 v[40:43], a[24:27], v[216:219], v[40:43]
  v_mfma_f32_16x16x32_bf16 v[44:47], a[28:31], v[216:219], v[44:47]
  s_add_u32 s25, s56, s75
  buffer_load_dwordx4 v[104:107], v5, s[4:7], s25 offen offset:2048 sc1
  s_waitcnt vmcnt(11)
  v_mfma_f32_16x16x32_bf16 v[28:31], a[52:55], v[220:223], v[28:31]
  v_mfma_f32_16x16x32_bf16 v[32:35], a[56:59], v[220:223], v[32:35]
  v_mfma_f32_16x16x32_bf16 v[36:39], a[60:63], v[220:223], v[36:39]
  v_mfma_f32_16x16x32_bf16 v[40:43], a[64:67], v[220:223], v[40:43]
  v_mfma_f32_16x16x32_bf16 v[44:47], a[68:71], v[220:223], v[44:47]
  buffer_load_dwordx4 v[108:111], v1, s[4:7], s25 offen offset:0 sc1
  s_waitcnt vmcnt(11)
  v_mfma_f32_16x16x32_bf16 v[48:51], a[92:95], v[224:227], v[48:51]
  v_mfma_f32_16x16x32_bf16 v[52:55], a[96:99], v[224:227], v[52:55]
  v_mfma_f32_16x16x32_bf16 v[56:59], a[100:103], v[224:227], v[56:59]
  ds_write_b128 v89, v[28:31] offset:0
  ds_write_b128 v89, v[32:35] offset:1024
  v_mfma_f32_16x16x32_bf16 v[60:63], a[104:107], v[224:227], v[60:63]
  ds_write_b128 v89, v[36:39] offset:2048
  ds_write_b128 v89, v[40:43] offset:3072
  v_mfma_f32_16x16x32_bf16 v[64:67], a[108:111], v[224:227], v[64:67]
  s_add_u32 s25, s56, s76
  buffer_load_dwordx4 v[112:115], v5, s[4:7], s25 offen offset:2048 sc1
  s_waitcnt vmcnt(11)
  v_mfma_f32_16x16x32_bf16 v[48:51], a[112:115], v[228:231], v[48:51]
  ds_write_b128 v89, v[44:47] offset:4096
  v_mfma_f32_16x16x32_bf16 v[52:55], a[116:119], v[228:231], v[52:55]
  v_mfma_f32_16x16x32_bf16 v[56:59], a[120:123], v[228:231], v[56:59]
  v_mfma_f32_16x16x32_bf16 v[60:63], a[124:127], v[228:231], v[60:63]
  v_mfma_f32_16x16x32_bf16 v[64:67], a[128:131], v[228:231], v[64:67]
  buffer_load_dwordx4 v[116:119], v1, s[4:7], s25 offen offset:0 sc1
  s_waitcnt vmcnt(11)
  v_mfma_f32_16x16x32_bf16 v[48:51], a[152:155], v[232:235], v[48:51]
  v_mfma_f32_16x16x32_bf16 v[52:55], a[156:159], v[232:235], v[52:55]
  v_mfma_f32_16x16x32_bf16 v[56:59], a[160:163], v[232:235], v[56:59]
  v_mfma_f32_16x16x32_bf16 v[60:63], a[164:167], v[232:235], v[60:63]
  v_mfma_f32_16x16x32_bf16 v[64:67], a[168:171], v[232:235], v[64:67]
  s_add_u32 s25, s56, s77
  buffer_load_dwordx4 v[120:123], v5, s[4:7], s25 offen offset:2048 sc1
  s_waitcnt vmcnt(11)
  v_mfma_f32_16x16x32_bf16 v[48:51], a[172:175], v[236:239], v[48:51]
  v_mfma_f32_16x16x32_bf16 v[52:55], a[176:179], v[236:239], v[52:55]
  v_mfma_f32_16x16x32_bf16 v[56:59], a[180:183], v[236:239], v[56:59]
  v_mfma_f32_16x16x32_bf16 v[60:63], a[184:187], v[236:239], v[60:63]
  v_mfma_f32_16x16x32_bf16 v[64:67], a[188:191], v[236:239], v[64:67]
  buffer_load_dwordx4 v[124:127], v1, s[4:7], s25 offen offset:0 sc1
  s_waitcnt vmcnt(11)
  v_mfma_f32_16x16x32_bf16 v[48:51], a[232:235], v[240:243], v[48:51]
  v_mfma_f32_16x16x32_bf16 v[52:55], a[236:239], v[240:243], v[52:55]
  v_mfma_f32_16x16x32_bf16 v[56:59], a[240:243], v[240:243], v[56:59]
  v_mfma_f32_16x16x32_bf16 v[60:63], a[244:247], v[240:243], v[60:63]
  v_mfma_f32_16x16x32_bf16 v[64:67], a[248:251], v[240:243], v[64:67]
  s_waitcnt vmcnt(10)
  v_mfma_f32_16x16x32_bf16 v[48:51], a[32:35], v[244:247], v[48:51]
  v_mfma_f32_16x16x32_bf16 v[52:55], a[36:39], v[244:247], v[52:55]
  v_mfma_f32_16x16x32_bf16 v[56:59], a[40:43], v[244:247], v[56:59]
  v_mfma_f32_16x16x32_bf16 v[60:63], a[44:47], v[244:247], v[60:63]
  v_mfma_f32_16x16x32_bf16 v[64:67], a[48:51], v[244:247], v[64:67]
  s_waitcnt vmcnt(9)
  v_mfma_f32_16x16x32_bf16 v[48:51], a[252:255], v[248:251], v[48:51]
  v_mfma_f32_16x16x32_bf16 v[52:55], a[16:19], v[248:251], v[52:55]
  v_mfma_f32_16x16x32_bf16 v[56:59], a[20:23], v[248:251], v[56:59]
  v_mfma_f32_16x16x32_bf16 v[60:63], a[24:27], v[248:251], v[60:63]
  v_mfma_f32_16x16x32_bf16 v[64:67], a[28:31], v[248:251], v[64:67]
  s_waitcnt vmcnt(8)
  v_mfma_f32_16x16x32_bf16 v[48:51], a[52:55], v[252:255], v[48:51]
  v_mfma_f32_16x16x32_bf16 v[52:55], a[56:59], v[252:255], v[52:55]
  v_mfma_f32_16x16x32_bf16 v[56:59], a[60:63], v[252:255], v[56:59]
  v_mfma_f32_16x16x32_bf16 v[60:63], a[64:67], v[252:255], v[60:63]
  v_mfma_f32_16x16x32_bf16 v[64:67], a[68:71], v[252:255], v[64:67]
  s_waitcnt vmcnt(7)
  v_mfma_f32_16x16x32_bf16 v[68:71], a[92:95], v[96:99], v[68:71]
  v_mfma_f32_16x16x32_bf16 v[72:75], a[96:99], v[96:99], v[72:75]
  v_mfma_f32_16x16x32_bf16 v[76:79], a[100:103], v[96:99], v[76:79]
  ds_write_b128 v90, v[48:51] offset:0
  ds_write_b128 v90, v[52:55] offset:1024
  v_mfma_f32_16x16x32_bf16 v[80:83], a[104:107], v[96:99], v[80:83]
  ds_write_b128 v90, v[56:59] offset:2048
  ds_write_b128 v90, v[60:63] offset:3072
  v_mfma_f32_16x16x32_bf16 v[84:87], a[108:111], v[96:99], v[84:87]
  ds_write_b128 v90, v[64:67] offset:4096
  s_waitcnt vmcnt(6)
  v_mfma_f32_16x16x32_bf16 v[68:71], a[112:115], v[100:103], v[68:71]
  v_mfma_f32_16x16x32_bf16 v[72:75], a[116:119], v[100:103], v[72:75]
  v_mfma_f32_16x16x32_bf16 v[76:79], a[120:123], v[100:103], v[76:79]
  v_mfma_f32_16x16x32_bf16 v[80:83], a[124:127], v[100:103], v[80:83]
  v_mfma_f32_16x16x32_bf16 v[84:87], a[128:131], v[100:103], v[84:87]
  s_waitcnt vmcnt(5)
  v_mfma_f32_16x16x32_bf16 v[68:71], a[152:155], v[104:107], v[68:71]
  s_waitcnt lgkmcnt(0)
  s_barrier
  v_mfma_f32_16x16x32_bf16 v[72:75], a[156:159], v[104:107], v[72:75]
  ds_read_b128 v[160:163], v91 offset:0
  ds_read_b128 v[164:167], v91 offset:1024
  v_mfma_f32_16x16x32_bf16 v[76:79], a[160:163], v[104:107], v[76:79]
  ds_read_b128 v[168:171], v91 offset:2048
  ds_read_b128 v[172:175], v91 offset:3072
  v_mfma_f32_16x16x32_bf16 v[80:83], a[164:167], v[104:107], v[80:83]
  ds_read_b128 v[176:179], v91 offset:4096
  ds_read_b128 v[180:183], v91 offset:5120
  v_mfma_f32_16x16x32_bf16 v[84:87], a[168:171], v[104:107], v[84:87]
  ds_read_b128 v[184:187], v91 offset:6144
  ds_read_b128 v[188:191], v91 offset:7168
  s_waitcnt vmcnt(4)
  v_mfma_f32_16x16x32_bf16 v[68:71], a[172:175], v[108:111], v[68:71]
  ds_read_b128 v[192:195], v91 offset:8192
  ds_read_b128 v[196:199], v91 offset:9216
  v_mfma_f32_16x16x32_bf16 v[72:75], a[176:179], v[108:111], v[72:75]
  ds_read_b128 v[200:203], v91 offset:10240
  ds_read_b128 v[204:207], v91 offset:11264
  v_mfma_f32_16x16x32_bf16 v[76:79], a[180:183], v[108:111], v[76:79]
  ds_read_b128 v[208:211], v91 offset:12288
  ds_read_b128 v[212:215], v91 offset:13312
  v_mfma_f32_16x16x32_bf16 v[80:83], a[184:187], v[108:111], v[80:83]
  ds_read_b128 v[216:219], v91 offset:14336
  s_waitcnt lgkmcnt(9)
  v_add_f32 v160, v160, v180
  v_mfma_f32_16x16x32_bf16 v[84:87], a[188:191], v[108:111], v[84:87]
  v_add_f32 v161, v161, v181
  v_add_f32 v162, v162, v182
  s_waitcnt vmcnt(3)
  v_mfma_f32_16x16x32_bf16 v[68:71], a[232:235], v[112:115], v[68:71]
  v_add_f32 v163, v163, v183
  s_waitcnt lgkmcnt(8)
  v_add_f32 v164, v164, v184
  v_mfma_f32_16x16x32_bf16 v[72:75], a[236:239], v[112:115], v[72:75]
  v_add_f32 v165, v165, v185
  v_add_f32 v166, v166, v186
  v_mfma_f32_16x16x32_bf16 v[76:79], a[240:243], v[112:115], v[76:79]
  v_add_f32 v167, v167, v187
  s_waitcnt lgkmcnt(7)
  v_add_f32 v168, v168, v188
  v_mfma_f32_16x16x32_bf16 v[80:83], a[244:247], v[112:115], v[80:83]
  v_add_f32 v169, v169, v189
  v_add_f32 v170, v170, v190
  v_mfma_f32_16x16x32_bf16 v[84:87], a[248:251], v[112:115], v[84:87]
  v_add_f32 v171, v171, v191
  s_waitcnt lgkmcnt(6)
  v_add_f32 v172, v172, v192
  s_waitcnt vmcnt(2)
  v_mfma_f32_16x16x32_bf16 v[68:71], a[32:35], v[116:119], v[68:71]
  v_add_f32 v173, v173, v193
  v_add_f32 v174, v174, v194
  v_mfma_f32_16x16x32_bf16 v[72:75], a[36:39], v[116:119], v[72:75]
  v_add_f32 v175, v175, v195
  s_waitcnt lgkmcnt(5)
  v_add_f32 v176, v176, v196
  v_mfma_f32_16x16x32_bf16 v[76:79], a[40:43], v[116:119], v[76:79]
  v_add_f32 v177, v177, v197
  v_add_f32 v178, v178, v198
  v_mfma_f32_16x16x32_bf16 v[80:83], a[44:47], v[116:119], v[80:83]
  v_add_f32 v179, v179, v199
  s_waitcnt lgkmcnt(4)
  v_add_f32 v160, v160, v200
  v_mfma_f32_16x16x32_bf16 v[84:87], a[48:51], v[116:119], v[84:87]
  v_add_f32 v161, v161, v201
  v_add_f32 v162, v162, v202
  s_waitcnt vmcnt(1)
  v_mfma_f32_16x16x32_bf16 v[68:71], a[252:255], v[120:123], v[68:71]
  v_add_f32 v163, v163, v203
  s_waitcnt lgkmcnt(3)
  v_add_f32 v164, v164, v204
  v_mfma_f32_16x16x32_bf16 v[72:75], a[16:19], v[120:123], v[72:75]
  v_add_f32 v165, v165, v205
  v_add_f32 v166, v166, v206
  v_mfma_f32_16x16x32_bf16 v[76:79], a[20:23], v[120:123], v[76:79]
  v_add_f32 v167, v167, v207
  s_waitcnt lgkmcnt(2)
  v_add_f32 v168, v168, v208
  v_mfma_f32_16x16x32_bf16 v[80:83], a[24:27], v[120:123], v[80:83]
  v_add_f32 v169, v169, v209
  v_add_f32 v170, v170, v210
  v_mfma_f32_16x16x32_bf16 v[84:87], a[28:31], v[120:123], v[84:87]
  v_add_f32 v171, v171, v211
  s_waitcnt lgkmcnt(1)
  v_add_f32 v172, v172, v212
  s_waitcnt vmcnt(0)
  v_mfma_f32_16x16x32_bf16 v[68:71], a[52:55], v[124:127], v[68:71]
  v_add_f32 v173, v173, v213
  v_add_f32 v174, v174, v214
  v_mfma_f32_16x16x32_bf16 v[72:75], a[56:59], v[124:127], v[72:75]
  v_add_f32 v175, v175, v215
  s_waitcnt lgkmcnt(0)
  v_add_f32 v176, v176, v216
  v_mfma_f32_16x16x32_bf16 v[76:79], a[60:63], v[124:127], v[76:79]
  v_add_f32 v177, v177, v217
  v_add_f32 v178, v178, v218
  v_mfma_f32_16x16x32_bf16 v[80:83], a[64:67], v[124:127], v[80:83]
  v_add_f32 v179, v179, v219
  v_mfma_f32_16x16x32_bf16 v[84:87], a[68:71], v[124:127], v[84:87]
  v_pk_add_f32 v[68:69], v[68:69], v[160:161]
  v_pk_add_f32 v[70:71], v[70:71], v[162:163]
  v_pk_add_f32 v[72:73], v[72:73], v[164:165]
  v_pk_add_f32 v[74:75], v[74:75], v[166:167]
  v_pk_add_f32 v[76:77], v[76:77], v[168:169]
  v_pk_add_f32 v[78:79], v[78:79], v[170:171]
  v_pk_add_f32 v[80:81], v[80:81], v[172:173]
  v_pk_add_f32 v[82:83], v[82:83], v[174:175]
  v_pk_add_f32 v[84:85], v[84:85], v[176:177]
  v_pk_add_f32 v[86:87], v[86:87], v[178:179]
  v_cvt_pk_bf16_f32 v8, v68, v69
  v_cvt_pk_bf16_f32 v9, v70, v71
  v_cvt_pk_bf16_f32 v10, v72, v73
  v_cvt_pk_bf16_f32 v11, v74, v75
  buffer_store_dwordx4 v[8:11], v6, s[8:11], s62 offen offset:0
  v_cvt_pk_bf16_f32 v12, v76, v77
  v_cvt_pk_bf16_f32 v13, v78, v79
  v_cvt_pk_bf16_f32 v14, v80, v81
  v_cvt_pk_bf16_f32 v15, v82, v83
  buffer_store_dwordx4 v[12:15], v6, s[8:11], s62 offen offset:64
  v_cvt_pk_bf16_f32 v16, v84, v85
  v_cvt_pk_bf16_f32 v17, v86, v87
  buffer_store_dwordx2 v[16:17], v7, s[8:11], s63 offen
  s_endpgm
E_p1_retry:
  buffer_load_dwordx4 v[160:163], off, s[4:7], s64 sc1
  s_add_u32 s67, s67, 1
  s_waitcnt vmcnt(0)
  v_and_b32 v160, v160, v161
  v_and_b32 v162, v162, v163
  v_and_b32 v160, v160, v162
  s_nop 1
  v_readfirstlane_b32 s66, v160
  s_cmp_gt_u32 s67, 0xffff
  s_cbranch_scc1 E_p1_ok
  s_bitcmp0_b32 s66, 0
  s_cbranch_scc1 E_p1_retry
  s_branch E_p1_ok
E_p2_retry:
  buffer_load_dwordx4 v[92:95], off, s[4:7], s64 sc1
  s_add_u32 s67, s67, 1
  s_waitcnt vmcnt(0)
  v_and_b32 v92, v92, v93
  v_and_b32 v94, v94, v95
  v_and_b32 v92, v92, v94
  s_nop 1
  v_readfirstlane_b32 s66, v92
  s_cmp_gt_u32 s67, 0xffff
  s_cbranch_scc1 E_p2_ok
  s_bitcmp0_b32 s66, 1
  s_cbranch_scc1 E_p2_retry
  s_branch E_p2_ok
E_end:
  s_endpgm
.p2align 8
code_end:
s_endpgm
.section .rodata,"a"
.p2align 6
.amdhsa_kernel kA_kernel
  .amdhsa_next_free_vgpr 168
  .amdhsa_next_free_sgpr 96
  .amdhsa_accum_offset 168
  .amdhsa_group_segment_fixed_size 0
  .amdhsa_kernarg_size 112
  .amdhsa_user_sgpr_count 2
  .amdhsa_user_sgpr_kernarg_segment_ptr 1
  .amdhsa_system_sgpr_workgroup_id_x 1
.end_amdhsa_kernel
.p2align 6
.amdhsa_kernel kC_kernel
  .amdhsa_next_free_vgpr 512
  .amdhsa_next_free_sgpr 96
  .amdhsa_accum_offset 256
  .amdhsa_group_segment_fixed_size 0
  .amdhsa_kernarg_size 112
  .amdhsa_user_sgpr_count 2
  .amdhsa_user_sgpr_kernarg_segment_ptr 1
  .amdhsa_system_sgpr_workgroup_id_x 1
.end_amdhsa_kernel
```
